```python
import torch

def _softmax(x, axis=-1):
    return torch.softmax(x, dim=axis)
def _gelu(x):
    return torch.nn.functional.gelu(x, approximate="tanh")
def _silu(x):
    return torch.nn.functional.silu(x)
def _sigmoid(x):
    return torch.sigmoid(x)
def _layernorm(x, axis=-1, eps=1e-5):
    m = x.mean(dim=axis, keepdim=True)
    v = x.var(dim=axis, keepdim=True, unbiased=False)
    return (x - m) / torch.sqrt(v + eps)
def _scatter_add(tgt, idx, src, axis=0):
    return tgt.clone().index_add_(axis, idx, src)
def _segment_sum(src, seg, n):
    out = torch.zeros((n,) + src.shape[1:], dtype=src.dtype)
    return out.index_add_(0, seg, src)
def _pad(x, pw):
    flat = tuple(v for pair in reversed(pw) for v in pair)
    return torch.nn.functional.pad(x, flat)

kernel_name = 'concat_heads__gqa_block_cached__gqa_block_cached__near_ridge'

def setup_inputs():

    _w = (lambda a: (lambda t: t.to(torch.bfloat16) if t.is_floating_point() else t)(torch.as_tensor(a)))
    def _A_setup():
        B, Sq, D = 16, 32, 1024
        Hq, Hkv, Sk, Dh = 32, 4, 1024, 128
        assert Hq % Hkv == 0, (Hq, Hkv)
        return {
            "x": _w((lambda *s: torch.randn(*s, dtype=torch.bfloat16) * 0.8)(B, Sq, D)),
            "k_cache": _w((lambda *s: torch.randn(*s, dtype=torch.bfloat16) * 0.8)(B, Hkv, Sk, Dh)),
            "v_cache": _w((lambda *s: torch.randn(*s, dtype=torch.bfloat16) * 0.05)(B, Hkv, Sk, Dh)),
            "wq": _w((lambda *s: torch.randn(*s, dtype=torch.bfloat16) * 0.8)(D, Hq * Dh) * (D ** -0.5)),
            "wo": _w((lambda *s: torch.randn(*s, dtype=torch.bfloat16) * 0.05)(Hq * Dh, D) * ((Hq * Dh) ** -0.5)),
        }
    _A_in = _A_setup()

    def _B_setup():
        B, Sq, D = 16, 32, 1024
        Hq, Hkv, Sk, Dh = 32, 4, 1024, 128
        assert Hq % Hkv == 0, (Hq, Hkv)
        return {
            "x": _w((lambda *s: torch.randn(*s, dtype=torch.bfloat16) * 0.8)(B, Sq, D)),
            "k_cache": _w((lambda *s: torch.randn(*s, dtype=torch.bfloat16) * 0.8)(B, Hkv, Sk, Dh)),
            "v_cache": _w((lambda *s: torch.randn(*s, dtype=torch.bfloat16) * 0.05)(B, Hkv, Sk, Dh)),
            "wq": _w((lambda *s: torch.randn(*s, dtype=torch.bfloat16) * 0.8)(D, Hq * Dh) * (D ** -0.5)),
            "wo": _w((lambda *s: torch.randn(*s, dtype=torch.bfloat16) * 0.05)(Hq * Dh, D) * ((Hq * Dh) ** -0.5)),
        }
    _B_in = _B_setup()

    return {
        "A_x": _A_in["x"],
        "A_k_cache": _A_in["k_cache"],
        "A_v_cache": _A_in["v_cache"],
        "A_wq": _A_in["wq"],
        "A_wo": _A_in["wo"],
        "B_x": _B_in["x"],
        "B_k_cache": _B_in["k_cache"],
        "B_v_cache": _B_in["v_cache"],
        "B_wq": _B_in["wq"],
        "B_wo": _B_in["wo"],
    }

def reference(A_x, A_k_cache, A_v_cache, A_wq, A_wo, B_x, B_k_cache, B_v_cache, B_wq, B_wo):
    def _A_ref(x, k_cache, v_cache, wq, wo):
        B, Sq, D = x.shape
        Hq, Dh = 32, 128
        Hkv = k_cache.shape[1]
        rep = Hq // Hkv
        q = (lambda x, *d: x.permute(*d))((x @ wq).reshape(B, Sq, Hq, Dh), 0, 2, 1, 3)
        k = (lambda x, n, axis: torch.repeat_interleave(x, n, dim=axis))(k_cache, rep, axis=1)
        v = (lambda x, n, axis: torch.repeat_interleave(x, n, dim=axis))(v_cache, rep, axis=1)
        scores = torch.einsum("bhqd,bhkd->bhqk", q, k) * (Dh ** -0.5)
        p = _softmax(scores, axis=-1)
        o = torch.einsum("bhqk,bhkd->bhqd", p, v)
        return (lambda x, *d: x.permute(*d))(o, 0, 2, 1, 3).reshape(B, Sq, Hq * Dh) @ wo

    def _B_ref(x, k_cache, v_cache, wq, wo):
        B, Sq, D = x.shape
        Hq, Dh = 32, 128
        Hkv = k_cache.shape[1]
        rep = Hq // Hkv
        q = (lambda x, *d: x.permute(*d))((x @ wq).reshape(B, Sq, Hq, Dh), 0, 2, 1, 3)
        k = (lambda x, n, axis: torch.repeat_interleave(x, n, dim=axis))(k_cache, rep, axis=1)
        v = (lambda x, n, axis: torch.repeat_interleave(x, n, dim=axis))(v_cache, rep, axis=1)
        scores = torch.einsum("bhqd,bhkd->bhqk", q, k) * (Dh ** -0.5)
        p = _softmax(scores, axis=-1)
        o = torch.einsum("bhqk,bhkd->bhqd", p, v)
        return (lambda x, *d: x.permute(*d))(o, 0, 2, 1, 3).reshape(B, Sq, Hq * Dh) @ wo

    a = _A_ref(A_x, A_k_cache, A_v_cache, A_wq, A_wo)
    b = _B_ref(B_x, B_k_cache, B_v_cache, B_wq, B_wo)
    return torch.concatenate([a, b], axis=-1)
```

```asm
; @launch grid=(256,1,1) block=(512,1,1) lds=163840
.amdgcn_target "amdgcn-amd-amdhsa--gfx950"
.text
.globl concat_heads__gqa_block_cached__gqa_block_cached__near_ridge_kernel
.p2align 8
.type concat_heads__gqa_block_cached__gqa_block_cached__near_ridge_kernel,@function
concat_heads__gqa_block_cached__gqa_block_cached__near_ridge_kernel:
    s_load_dwordx16 s[16:31], s[0:1], 0
    s_load_dwordx8 s[32:39], s[0:1], 64
    s_load_dwordx2 s[40:41], s[0:1], 96
    s_cmp_ge_u32 s2, 256
    s_cbranch_scc1 L_end
    v_lshrrev_b32 v1, 6, v0
    v_and_b32 v0, 63, v0
    v_readfirstlane_b32 s48, v1
    s_bfe_u32 s42, s2, 0x10002
    s_and_b32 s43, s2, 3
    s_lshr_b32 s44, s2, 3
    s_lshr_b32 s45, s2, 4
    s_and_b32 s46, s44, 1
    s_lshr_b32 s47, s2, 6
    s_and_b32 s7, s48, 3
    s_and_b32 s49, s45, 3
    s_lshl_b32 s50, s46, 2
    s_add_u32 s49, s49, s50
    s_lshl_b32 s50, s43, 3
    s_add_u32 s55, s49, s50
    v_lshrrev_b32 v1, 3, v0
    s_lshl_b32 s50, s7, 3
    v_add_u32 v1, s50, v1
    v_lshrrev_b32 v2, 1, v1
    v_xor_b32 v2, v2, v0
    v_and_b32 v2, 7, v2
    v_lshlrev_b32 v2, 4, v2
    v_lshl_add_u32 v252, v1, 11, v2
    v_lshrrev_b32 v1, 4, v0
    s_lshl_b32 s50, s7, 2
    v_add_u32 v2, s50, v1
    s_and_b32 s50, s7, 2
    s_lshl_b32 s50, s50, 2
    v_lshl_add_u32 v3, v1, 1, s50
    v_xor_b32 v3, v3, v0
    v_and_b32 v3, 15, v3
    v_lshlrev_b32 v7, 4, v3
    v_lshl_add_u32 v253, v2, 13, v7
    s_mul_i32 s80, s47, 2
    s_mul_i32 s81, s49, 2
    s_add_u32 s4, s80, s81
    s_and_b32 s4, s4, 15
    s_mov_b32 s78, 0x65498321
    s_mov_b32 s79, 0xfedcba7
    s_lshl_b32 s3, s7, 10
    s_lshl_b32 s49, s47, 18
    s_lshl_b32 s50, s55, 8
    s_mov_b32 s53, 0
    s_cmp_eq_u32 s42, 0
    s_waitcnt lgkmcnt(0)
    s_cselect_b64 s[16:17], s[16:17], s[26:27]
    s_cselect_b64 s[18:19], s[18:19], s[28:29]
    s_cselect_b64 s[20:21], s[20:21], s[30:31]
    s_cselect_b64 s[22:23], s[22:23], s[32:33]
    s_cselect_b64 s[24:25], s[24:25], s[34:35]
    s_add_u32 s60, s16, s49
    s_addc_u32 s61, s17, 0
    s_mov_b32 s62, 262144
    s_mov_b32 s63, 0x20000
    s_add_u32 s56, s22, s50
    s_addc_u32 s57, s23, 0
    s_mov_b32 s58, 8380672
    s_mov_b32 s59, 0x20000
    s_cmp_lt_u32 s48, 4
    s_cbranch_scc1 g_compute
    s_mov_b32 s8, s3
la_pre:
    s_lshl_b32 s51, s4, 7
    s_lshl_b32 s54, s4, 19
    s_add_u32 m0, s3, 65536
    s_nop 0
    buffer_load_dwordx4 v253, s[56:59], s54 offen  lds
    s_add_u32 m0, s3, 32768
    s_nop 0
    buffer_load_dwordx4 v252, s[60:63], s51 offen  lds
    s_add_u32 m0, s3, 69632
    s_add_u32 s54, s54, 131072
    buffer_load_dwordx4 v253, s[56:59], s54 offen  lds
    s_add_u32 m0, s3, 36864
    s_add_u32 s51, s51, 65536
    buffer_load_dwordx4 v252, s[60:63], s51 offen  lds
    s_add_u32 m0, s3, 73728
    s_add_u32 s54, s54, 131072
    buffer_load_dwordx4 v253, s[56:59], s54 offen  lds
    s_add_u32 m0, s3, 40960
    s_add_u32 s51, s51, 65536
    buffer_load_dwordx4 v252, s[60:63], s51 offen  lds
    s_add_u32 m0, s3, 77824
    s_add_u32 s54, s54, 131072
    buffer_load_dwordx4 v253, s[56:59], s54 offen  lds
    s_add_u32 m0, s3, 45056
    s_add_u32 s51, s51, 65536
    buffer_load_dwordx4 v252, s[60:63], s51 offen  lds
    s_add_u32 s3, s3, 16384
    s_and_b32 s51, s3, 0x8000
    s_mul_i32 s51, s51, 3
    s_xor_b32 s3, s3, s51
    s_add_u32 s4, s78, s80
    s_and_b32 s4, s4, 7
    s_and_b32 s51, s78, 8
    s_add_u32 s4, s4, s51
    s_add_u32 s4, s4, s81
    s_and_b32 s4, s4, 15
    s_lshr_b64 s[78:79], s[78:79], 4
    s_add_u32 s53, s53, 1
    s_cmp_lt_u32 s53, 3
    s_cbranch_scc1 la_pre
    s_mov_b32 s3, s8
    s_add_u32 s84, s80, 3
    s_and_b32 s84, s84, 7
    s_add_u32 s84, s84, s81
    s_and_b32 s84, s84, 15
    s_lshl_b32 s85, s84, 19
    s_lshl_b32 s84, s84, 7
    s_add_u32 m0, s8, 147456
    s_waitcnt vmcnt(16)
    s_barrier
    buffer_load_dwordx4 v253, s[56:59], s85 offen  lds
    s_add_u32 m0, s8, 114688
    s_add_u32 s82, s80, 0
    s_and_b32 s82, s82, 7
    buffer_load_dwordx4 v252, s[60:63], s84 offen  lds
    s_add_u32 m0, s8, 151552
    s_add_u32 s85, s85, 131072
    s_add_u32 s82, s82, s81
    s_add_u32 s82, s82, 8
    buffer_load_dwordx4 v253, s[56:59], s85 offen  lds
    s_add_u32 m0, s8, 118784
    s_add_u32 s84, s84, 65536
    s_and_b32 s82, s82, 15
    s_lshl_b32 s83, s82, 19
    buffer_load_dwordx4 v252, s[60:63], s84 offen  lds
    s_add_u32 m0, s8, 155648
    s_add_u32 s85, s85, 131072
    s_lshl_b32 s82, s82, 7
    buffer_load_dwordx4 v253, s[56:59], s85 offen  lds
    s_add_u32 m0, s8, 122880
    s_add_u32 s84, s84, 65536
    buffer_load_dwordx4 v252, s[60:63], s84 offen  lds
    s_add_u32 m0, s8, 159744
    s_add_u32 s85, s85, 131072
    buffer_load_dwordx4 v253, s[56:59], s85 offen  lds
    s_add_u32 m0, s8, 126976
    s_add_u32 s84, s84, 65536
    buffer_load_dwordx4 v252, s[60:63], s84 offen  lds
    s_add_u32 m0, s8, 65536
    s_waitcnt vmcnt(16)
    s_barrier
    buffer_load_dwordx4 v253, s[56:59], s83 offen  lds
    s_add_u32 m0, s8, 32768
    s_add_u32 s84, s80, 1
    s_and_b32 s84, s84, 7
    s_add_u32 s84, s84, s81
    s_add_u32 s84, s84, 8
    s_and_b32 s84, s84, 15
    s_lshl_b32 s85, s84, 19
    buffer_load_dwordx4 v252, s[60:63], s82 offen  lds
    s_add_u32 m0, s8, 69632
    s_add_u32 s83, s83, 131072
    s_lshl_b32 s84, s84, 7
    s_mov_b32 s64, s40
    s_mov_b32 s65, s41
    s_mov_b32 s66, 268435456
    s_mov_b32 s67, 0x20000
    s_lshl_b32 s49, s45, 2
    buffer_load_dwordx4 v253, s[56:59], s83 offen  lds
    s_add_u32 m0, s8, 36864
    s_add_u32 s82, s82, 65536
    s_add_u32 s49, s49, s43
    s_lshl_b32 s49, s49, 18
    s_add_u32 s68, s18, s49
    s_addc_u32 s69, s19, 0
    s_mov_b32 s70, 262144
    s_mov_b32 s71, 0x20000
    s_add_u32 s28, s20, s49
    s_addc_u32 s29, s21, 0
    buffer_load_dwordx4 v252, s[60:63], s82 offen  lds
    s_add_u32 m0, s8, 73728
    s_add_u32 s83, s83, 131072
    s_mov_b32 s30, 262144
    s_mov_b32 s31, 0x20000
    s_and_b32 s27, s2, 7
    s_lshl_b32 s27, s27, 2
    s_add_u32 s27, s27, s47
    s_and_b32 s49, s2, 0xfc
    buffer_load_dwordx4 v253, s[56:59], s83 offen  lds
    s_add_u32 m0, s8, 40960
    s_add_u32 s82, s82, 65536
    s_lshl_b32 s49, s49, 15
    s_lshl_b32 s50, s43, 3
    s_add_u32 s50, s50, s48
    s_lshl_b32 s50, s50, 10
    s_add_u32 s49, s49, s50
    s_add_u32 s0, s49, 16777216
    buffer_load_dwordx4 v252, s[60:63], s82 offen  lds
    s_add_u32 m0, s8, 77824
    s_add_u32 s83, s83, 131072
    v_lshlrev_b32 v27, 4, v0
    s_lshl_b32 s50, s48, 11
    s_add_u32 s50, s50, 131072
    v_add_u32 v248, s50, v27
    buffer_load_dwordx4 v253, s[56:59], s83 offen  lds
    s_add_u32 m0, s8, 45056
    s_add_u32 s82, s82, 65536
    buffer_load_dwordx4 v252, s[60:63], s82 offen  lds
    s_add_u32 m0, s8, 81920
    s_waitcnt vmcnt(16)
    s_barrier
    buffer_load_dwordx4 v253, s[56:59], s85 offen  lds
    s_add_u32 m0, s8, 49152
    s_add_u32 s82, s80, 4
    s_and_b32 s82, s82, 7
    s_add_u32 s82, s82, s81
    s_and_b32 s82, s82, 15
    s_lshl_b32 s83, s82, 19
    s_lshl_b32 s82, s82, 7
    buffer_load_dwordx4 v252, s[60:63], s84 offen  lds
    s_add_u32 m0, s8, 86016
    s_add_u32 s85, s85, 131072
    s_load_dword s14, s[38:39], 0
    s_mov_b32 s32, s36
    s_mov_b32 s33, s37
    s_mov_b32 s34, 2097152
    s_mov_b32 s35, 0x20000
    v_and_b32 v3, 15, v0
    buffer_load_dwordx4 v253, s[56:59], s85 offen  lds
    s_add_u32 m0, s8, 53248
    s_add_u32 s84, s84, 65536
    v_lshlrev_b32 v3, 12, v3
    v_bfe_u32 v4, v0, 4, 1
    v_lshl_add_u32 v3, v4, 5, v3
    v_lshrrev_b32 v4, 5, v0
    v_lshl_add_u32 v249, v4, 4, v3
    s_lshl_b32 s49, s47, 2
    buffer_load_dwordx4 v252, s[60:63], s84 offen  lds
    s_add_u32 m0, s8, 90112
    s_add_u32 s85, s85, 131072
    s_add_u32 s49, s49, s43
    s_lshl_b32 s49, s49, 1
    s_bfe_u32 s50, s48, 0x10001
    s_add_u32 s49, s49, s50
    s_lshl_b32 s49, s49, 16
    s_lshl_b32 s50, s42, 11
    buffer_load_dwordx4 v253, s[56:59], s85 offen  lds
    s_add_u32 m0, s8, 57344
    s_add_u32 s84, s84, 65536
    s_add_u32 s49, s49, s50
    s_and_b32 s50, s44, 7
    s_lshl_b32 s50, s50, 8
    s_add_u32 s49, s49, s50
    s_lshr_b32 s50, s48, 2
    s_lshl_b32 s50, s50, 7
    buffer_load_dwordx4 v252, s[60:63], s84 offen  lds
    s_add_u32 m0, s8, 94208
    s_add_u32 s85, s85, 131072
    s_add_u32 s49, s49, s50
    s_and_b32 s50, s48, 1
    s_lshl_b32 s50, s50, 6
    s_add_u32 s1, s49, s50
    buffer_load_dwordx4 v253, s[56:59], s85 offen  lds
    s_add_u32 m0, s8, 61440
    s_add_u32 s84, s84, 65536
    buffer_load_dwordx4 v252, s[60:63], s84 offen  lds
    s_add_u32 m0, s8, 131072
    s_waitcnt vmcnt(16)
    s_barrier
    buffer_load_dwordx4 v253, s[56:59], s83 offen  lds
    s_add_u32 m0, s8, 98304
    s_add_u32 s84, s80, 5
    s_and_b32 s84, s84, 7
    s_add_u32 s84, s84, s81
    s_and_b32 s84, s84, 15
    s_lshl_b32 s85, s84, 19
    s_lshl_b32 s84, s84, 7
    buffer_load_dwordx4 v252, s[60:63], s82 offen  lds
    s_add_u32 m0, s8, 135168
    s_add_u32 s83, s83, 131072
    v_xor_b32 v3, v2, v0
    v_and_b32 v3, 15, v3
    v_lshlrev_b32 v3, 4, v3
    v_lshl_add_u32 v20, v2, 8, v3
    v_lshlrev_b32 v3, 2, v1
    v_xor_b32 v3, v3, v0
    buffer_load_dwordx4 v253, s[56:59], s83 offen  lds
    s_add_u32 m0, s8, 102400
    s_add_u32 s82, s82, 65536
    v_and_b32 v3, 15, v3
    v_lshlrev_b32 v3, 4, v3
    v_lshl_add_u32 v21, v2, 8, v3
    s_and_b32 s50, s44, 7
    s_mul_i32 s49, s47, 4
    s_mul_i32 s50, s50, 2
    buffer_load_dwordx4 v252, s[60:63], s82 offen  lds
    s_add_u32 m0, s8, 139264
    s_add_u32 s83, s83, 131072
    s_add_u32 s13, s49, s50
    s_and_b32 s13, s13, 15
    v_add_u32 v23, s3, v27
    s_mov_b32 s8, s3
    s_and_b32 s50, s7, 2
    s_lshl_b32 s50, s50, 1
    buffer_load_dwordx4 v253, s[56:59], s83 offen  lds
    s_add_u32 m0, s8, 106496
    s_add_u32 s82, s82, 65536
    s_and_b32 s49, s7, 1
    s_lshl_b32 s49, s49, 3
    s_add_u32 s49, s49, s50
    v_add_u32 v3, s49, v1
    v_lshl_add_u32 v22, v3, 11, v7
    s_and_b32 s49, s2, 7
    buffer_load_dwordx4 v252, s[60:63], s82 offen  lds
    s_add_u32 m0, s8, 143360
    s_add_u32 s83, s83, 131072
    s_mul_i32 s49, s49, 6
    s_add_u32 s49, s49, s45
    s_mul_i32 s49, s49, 1
    buffer_load_dwordx4 v253, s[56:59], s83 offen  lds
    s_add_u32 m0, s8, 110592
    s_add_u32 s82, s82, 65536
    buffer_load_dwordx4 v252, s[60:63], s82 offen  lds
    s_add_u32 m0, s8, 147456
    s_waitcnt vmcnt(16)
    s_barrier
    buffer_load_dwordx4 v253, s[56:59], s85 offen  lds
    s_add_u32 m0, s8, 114688
    s_add_u32 s82, s80, 6
    s_and_b32 s82, s82, 7
    s_add_u32 s82, s82, s81
    s_and_b32 s82, s82, 15
    s_lshl_b32 s83, s82, 19
    s_lshl_b32 s82, s82, 7
    buffer_load_dwordx4 v252, s[60:63], s84 offen  lds
    s_add_u32 m0, s8, 151552
    s_add_u32 s85, s85, 131072
    s_mul_i32 s50, s46, 10
    s_add_u32 s49, s49, s50
    s_and_b32 s49, s49, 15
    s_lshl_b32 s9, s49, 14
    s_lshl_b32 s49, s46, 2
    s_add_u32 s49, s49, s7
    buffer_load_dwordx4 v253, s[56:59], s85 offen  lds
    s_add_u32 m0, s8, 118784
    s_add_u32 s84, s84, 65536
    s_lshl_b32 s49, s49, 3
    s_and_b32 s50, s45, 3
    s_add_u32 s49, s49, s50
    s_lshl_b32 s49, s49, 12
    s_lshl_b32 s50, s27, 19
    s_add_u32 s6, s49, s50
    buffer_load_dwordx4 v252, s[60:63], s84 offen  lds
    s_add_u32 m0, s8, 155648
    s_add_u32 s85, s85, 131072
    v_and_b32 v3, 31, v0
    v_lshlrev_b32 v3, 7, v3
    v_lshrrev_b32 v4, 5, v0
    v_lshl_add_u32 v29, v4, 14, v3
    v_and_b32 v3, 31, v0
    v_lshlrev_b32 v24, 3, v3
    buffer_load_dwordx4 v253, s[56:59], s85 offen  lds
    s_add_u32 m0, s8, 122880
    s_add_u32 s84, s84, 65536
    v_and_b32 v3, 15, v0
    v_lshlrev_b32 v25, 3, v3
    s_lshl_b32 s49, s27, 19
    s_add_u32 s10, s49, 266240
    s_and_b32 s49, s2, 0xfc
    s_lshl_b32 s49, s49, 5
    buffer_load_dwordx4 v252, s[60:63], s84 offen  lds
    s_add_u32 m0, s8, 159744
    s_add_u32 s85, s85, 131072
    s_add_u32 s11, s49, 25165824
    buffer_load_dwordx4 v253, s[56:59], s85 offen  lds
    s_add_u32 m0, s8, 126976
    s_add_u32 s84, s84, 65536
    buffer_load_dwordx4 v252, s[60:63], s84 offen  lds
    s_add_u32 m0, s8, 65536
    s_waitcnt vmcnt(16)
    s_barrier
    buffer_load_dwordx4 v253, s[56:59], s83 offen  lds
    s_add_u32 m0, s8, 32768
    s_add_u32 s84, s80, 7
    s_and_b32 s84, s84, 7
    s_add_u32 s84, s84, s81
    buffer_load_dwordx4 v252, s[60:63], s82 offen  lds
    s_add_u32 m0, s8, 69632
    s_add_u32 s83, s83, 131072
    s_and_b32 s84, s84, 15
    s_lshl_b32 s85, s84, 19
    s_lshl_b32 s84, s84, 7
    buffer_load_dwordx4 v253, s[56:59], s83 offen  lds
    s_add_u32 m0, s8, 36864
    s_add_u32 s82, s82, 65536
    s_getreg_b32 s86, hwreg(HW_REG_XCC_ID, 0, 4)
    s_and_b32 s86, s86, 7
    s_lshl_b32 s88, s27, 19
    buffer_load_dwordx4 v252, s[60:63], s82 offen  lds
    s_add_u32 m0, s8, 73728
    s_add_u32 s83, s83, 131072
    s_add_u32 s88, s88, 290816
    s_and_b32 s49, s44, 7
    s_lshl_b32 s49, s49, 2
    buffer_load_dwordx4 v253, s[56:59], s83 offen  lds
    s_add_u32 m0, s8, 40960
    s_add_u32 s82, s82, 65536
    v_mov_b32 v4, s49
    buffer_load_dwordx4 v252, s[60:63], s82 offen  lds
    s_add_u32 m0, s8, 77824
    s_add_u32 s83, s83, 131072
    buffer_load_dwordx4 v253, s[56:59], s83 offen  lds
    s_add_u32 m0, s8, 45056
    s_add_u32 s82, s82, 65536
    buffer_load_dwordx4 v252, s[60:63], s82 offen  lds
    s_waitcnt lgkmcnt(0)
    s_cmp_eq_u32 s14, 0
    s_cbranch_scc1 n_spin
n_back:
    s_lshl1_add_u32 s86, s86, s14
    s_cmp_lg_u32 s7, 0
    s_cbranch_scc1 n_not
    v_mov_b32 v3, s86
    s_mov_b64 exec, 1
    buffer_store_dword v3, v4, s[64:67], s88 offen sc1
    s_mov_b64 exec, -1
n_not:
    s_add_u32 s51, s9, 0
    s_and_b32 s51, s51, 0x3ffff
    s_add_u32 m0, s8, 0
    s_nop 0
    buffer_load_dwordx4 v20, s[68:71], s51 offen nt lds
    s_add_u32 m0, s8, 4096
    s_add_u32 s51, s51, 4096
    buffer_load_dwordx4 v20, s[68:71], s51 offen nt lds
    s_add_u32 m0, s8, 8192
    s_add_u32 s51, s51, 4096
    buffer_load_dwordx4 v20, s[68:71], s51 offen nt lds
    s_add_u32 m0, s8, 12288
    s_add_u32 s51, s51, 4096
    buffer_load_dwordx4 v20, s[68:71], s51 offen nt lds
    s_add_u32 s51, s9, 16384
    s_and_b32 s51, s51, 0x3ffff
    s_add_u32 m0, s8, 16384
    s_nop 0
    buffer_load_dwordx4 v20, s[68:71], s51 offen nt lds
    s_add_u32 m0, s8, 20480
    s_add_u32 s51, s51, 4096
    buffer_load_dwordx4 v20, s[68:71], s51 offen nt lds
    s_add_u32 m0, s8, 24576
    s_add_u32 s51, s51, 4096
    buffer_load_dwordx4 v20, s[68:71], s51 offen nt lds
    s_add_u32 m0, s8, 28672
    s_add_u32 s51, s51, 4096
    buffer_load_dwordx4 v20, s[68:71], s51 offen nt lds
    s_add_u32 m0, s8, 81920
    s_waitcnt vmcnt(24)
    s_barrier
    buffer_load_dwordx4 v253, s[56:59], s85 offen  lds
    s_add_u32 m0, s8, 49152
    s_add_u32 s82, s80, 2
    s_and_b32 s82, s82, 7
    buffer_load_dwordx4 v252, s[60:63], s84 offen  lds
    s_add_u32 m0, s8, 86016
    s_add_u32 s85, s85, 131072
    s_add_u32 s82, s82, s81
    s_add_u32 s82, s82, 8
    buffer_load_dwordx4 v253, s[56:59], s85 offen  lds
    s_add_u32 m0, s8, 53248
    s_add_u32 s84, s84, 65536
    s_and_b32 s82, s82, 15
    s_lshl_b32 s83, s82, 19
    buffer_load_dwordx4 v252, s[60:63], s84 offen  lds
    s_add_u32 m0, s8, 90112
    s_add_u32 s85, s85, 131072
    s_lshl_b32 s82, s82, 7
    buffer_load_dwordx4 v253, s[56:59], s85 offen  lds
    s_add_u32 m0, s8, 57344
    s_add_u32 s84, s84, 65536
    buffer_load_dwordx4 v252, s[60:63], s84 offen  lds
    s_add_u32 m0, s8, 94208
    s_add_u32 s85, s85, 131072
    buffer_load_dwordx4 v253, s[56:59], s85 offen  lds
    s_add_u32 m0, s8, 61440
    s_add_u32 s84, s84, 65536
    buffer_load_dwordx4 v252, s[60:63], s84 offen  lds
    s_add_u32 m0, s8, 131072
    s_waitcnt vmcnt(24)
    s_barrier
    buffer_load_dwordx4 v253, s[56:59], s83 offen  lds
    s_add_u32 m0, s8, 98304
    s_add_u32 s84, s80, 3
    s_and_b32 s84, s84, 7
    buffer_load_dwordx4 v252, s[60:63], s82 offen  lds
    s_add_u32 m0, s8, 135168
    s_add_u32 s83, s83, 131072
    s_add_u32 s84, s84, s81
    s_add_u32 s84, s84, 8
    buffer_load_dwordx4 v253, s[56:59], s83 offen  lds
    s_add_u32 m0, s8, 102400
    s_add_u32 s82, s82, 65536
    s_and_b32 s84, s84, 15
    s_lshl_b32 s85, s84, 19
    buffer_load_dwordx4 v252, s[60:63], s82 offen  lds
    s_add_u32 m0, s8, 139264
    s_add_u32 s83, s83, 131072
    s_lshl_b32 s84, s84, 7
    buffer_load_dwordx4 v253, s[56:59], s83 offen  lds
    s_add_u32 m0, s8, 106496
    s_add_u32 s82, s82, 65536
    buffer_load_dwordx4 v252, s[60:63], s82 offen  lds
    s_add_u32 m0, s8, 143360
    s_add_u32 s83, s83, 131072
    buffer_load_dwordx4 v253, s[56:59], s83 offen  lds
    s_add_u32 m0, s8, 110592
    s_add_u32 s82, s82, 65536
    buffer_load_dwordx4 v252, s[60:63], s82 offen  lds
    s_add_u32 m0, s8, 147456
    s_waitcnt vmcnt(24)
    s_barrier
    buffer_load_dwordx4 v253, s[56:59], s85 offen  lds
    s_add_u32 m0, s8, 114688
    s_add_u32 s82, s80, 4
    s_and_b32 s82, s82, 7
    buffer_load_dwordx4 v252, s[60:63], s84 offen  lds
    s_add_u32 m0, s8, 151552
    s_add_u32 s85, s85, 131072
    s_add_u32 s82, s82, s81
    s_add_u32 s82, s82, 8
    buffer_load_dwordx4 v253, s[56:59], s85 offen  lds
    s_add_u32 m0, s8, 118784
    s_add_u32 s84, s84, 65536
    s_and_b32 s82, s82, 15
    s_lshl_b32 s83, s82, 19
    buffer_load_dwordx4 v252, s[60:63], s84 offen  lds
    s_add_u32 m0, s8, 155648
    s_add_u32 s85, s85, 131072
    s_lshl_b32 s82, s82, 7
    buffer_load_dwordx4 v253, s[56:59], s85 offen  lds
    s_add_u32 m0, s8, 122880
    s_add_u32 s84, s84, 65536
    buffer_load_dwordx4 v252, s[60:63], s84 offen  lds
    s_add_u32 m0, s8, 159744
    s_add_u32 s85, s85, 131072
    buffer_load_dwordx4 v253, s[56:59], s85 offen  lds
    s_add_u32 m0, s8, 126976
    s_add_u32 s84, s84, 65536
    buffer_load_dwordx4 v252, s[60:63], s84 offen  lds
    s_add_u32 m0, s8, 65536
    s_waitcnt vmcnt(16)
    s_barrier
    buffer_load_dwordx4 v253, s[56:59], s83 offen  lds
    s_add_u32 m0, s8, 32768
    s_add_u32 s84, s80, 5
    s_and_b32 s84, s84, 7
    buffer_load_dwordx4 v252, s[60:63], s82 offen  lds
    s_add_u32 m0, s8, 69632
    s_add_u32 s83, s83, 131072
    s_add_u32 s84, s84, s81
    s_add_u32 s84, s84, 8
    buffer_load_dwordx4 v253, s[56:59], s83 offen  lds
    s_add_u32 m0, s8, 36864
    s_add_u32 s82, s82, 65536
    s_and_b32 s84, s84, 15
    s_lshl_b32 s85, s84, 19
    buffer_load_dwordx4 v252, s[60:63], s82 offen  lds
    s_add_u32 m0, s8, 73728
    s_add_u32 s83, s83, 131072
    s_lshl_b32 s84, s84, 7
    buffer_load_dwordx4 v253, s[56:59], s83 offen  lds
    s_add_u32 m0, s8, 40960
    s_add_u32 s82, s82, 65536
    buffer_load_dwordx4 v252, s[60:63], s82 offen  lds
    s_add_u32 m0, s8, 77824
    s_add_u32 s83, s83, 131072
    buffer_load_dwordx4 v253, s[56:59], s83 offen  lds
    s_add_u32 m0, s8, 45056
    s_add_u32 s82, s82, 65536
    buffer_load_dwordx4 v252, s[60:63], s82 offen  lds
    s_add_u32 m0, s8, 81920
    s_waitcnt vmcnt(16)
    s_barrier
    buffer_load_dwordx4 v253, s[56:59], s85 offen  lds
    s_add_u32 m0, s8, 49152
    s_add_u32 s82, s80, 6
    s_and_b32 s82, s82, 7
    buffer_load_dwordx4 v252, s[60:63], s84 offen  lds
    s_add_u32 m0, s8, 86016
    s_add_u32 s85, s85, 131072
    s_add_u32 s82, s82, s81
    s_add_u32 s82, s82, 8
    buffer_load_dwordx4 v253, s[56:59], s85 offen  lds
    s_add_u32 m0, s8, 53248
    s_add_u32 s84, s84, 65536
    s_and_b32 s82, s82, 15
    s_lshl_b32 s83, s82, 19
    buffer_load_dwordx4 v252, s[60:63], s84 offen  lds
    s_add_u32 m0, s8, 90112
    s_add_u32 s85, s85, 131072
    s_lshl_b32 s82, s82, 7
    buffer_load_dwordx4 v253, s[56:59], s85 offen  lds
    s_add_u32 m0, s8, 57344
    s_add_u32 s84, s84, 65536
    buffer_load_dwordx4 v252, s[60:63], s84 offen  lds
    s_add_u32 m0, s8, 94208
    s_add_u32 s85, s85, 131072
    buffer_load_dwordx4 v253, s[56:59], s85 offen  lds
    s_add_u32 m0, s8, 61440
    s_add_u32 s84, s84, 65536
    buffer_load_dwordx4 v252, s[60:63], s84 offen  lds
    s_add_u32 m0, s8, 131072
    s_waitcnt vmcnt(16)
    s_barrier
    buffer_load_dwordx4 v253, s[56:59], s83 offen  lds
    s_add_u32 m0, s8, 98304
    s_add_u32 s84, s80, 7
    s_and_b32 s84, s84, 7
    buffer_load_dwordx4 v252, s[60:63], s82 offen  lds
    s_add_u32 m0, s8, 135168
    s_add_u32 s83, s83, 131072
    s_add_u32 s84, s84, s81
    s_add_u32 s84, s84, 8
    buffer_load_dwordx4 v253, s[56:59], s83 offen  lds
    s_add_u32 m0, s8, 102400
    s_add_u32 s82, s82, 65536
    s_and_b32 s84, s84, 15
    s_lshl_b32 s85, s84, 19
    buffer_load_dwordx4 v252, s[60:63], s82 offen  lds
    s_add_u32 m0, s8, 139264
    s_add_u32 s83, s83, 131072
    s_lshl_b32 s84, s84, 7
    buffer_load_dwordx4 v253, s[56:59], s83 offen  lds
    s_add_u32 m0, s8, 106496
    s_add_u32 s82, s82, 65536
    buffer_load_dwordx4 v252, s[60:63], s82 offen  lds
    s_add_u32 m0, s8, 143360
    s_add_u32 s83, s83, 131072
    buffer_load_dwordx4 v253, s[56:59], s83 offen  lds
    s_add_u32 m0, s8, 110592
    s_add_u32 s82, s82, 65536
    buffer_load_dwordx4 v252, s[60:63], s82 offen  lds
    s_add_u32 m0, s8, 147456
    s_waitcnt vmcnt(16)
    s_barrier
    buffer_load_dwordx4 v253, s[56:59], s85 offen  lds
    s_add_u32 m0, s8, 114688
    s_load_dwordx8 s[72:79], s[40:41], s88
    buffer_load_dwordx4 v252, s[60:63], s84 offen  lds
    s_add_u32 m0, s8, 151552
    s_add_u32 s85, s85, 131072
    buffer_load_dwordx4 v253, s[56:59], s85 offen  lds
    s_add_u32 m0, s8, 118784
    s_add_u32 s84, s84, 65536
    buffer_load_dwordx4 v252, s[60:63], s84 offen  lds
    s_add_u32 m0, s8, 155648
    s_add_u32 s85, s85, 131072
    buffer_load_dwordx4 v253, s[56:59], s85 offen  lds
    s_add_u32 m0, s8, 122880
    s_add_u32 s84, s84, 65536
    buffer_load_dwordx4 v252, s[60:63], s84 offen  lds
    s_add_u32 m0, s8, 159744
    s_add_u32 s85, s85, 131072
    buffer_load_dwordx4 v253, s[56:59], s85 offen  lds
    s_add_u32 m0, s8, 126976
    s_add_u32 s84, s84, 65536
    buffer_load_dwordx4 v252, s[60:63], s84 offen  lds
    s_waitcnt vmcnt(16)
    s_barrier
la_x:
    buffer_load_dword v7, v29, s[64:67], s6 offen
    s_xor_b32 s15, s14, 0x5bd1e995
    s_waitcnt vmcnt(9)
    s_barrier
    s_add_u32 s51, s9, 0
    s_and_b32 s51, s51, 0x3ffff
    s_add_u32 m0, s8, 32768
    s_nop 0
    buffer_load_dwordx4 v21, s[28:31], s51 offen nt lds
    s_add_u32 m0, s8, 36864
    s_add_u32 s51, s51, 4096
    buffer_load_dwordx4 v21, s[28:31], s51 offen nt lds
    s_add_u32 m0, s8, 40960
    s_add_u32 s51, s51, 4096
    buffer_load_dwordx4 v21, s[28:31], s51 offen nt lds
    s_add_u32 m0, s8, 45056
    s_add_u32 s51, s51, 4096
    buffer_load_dwordx4 v21, s[28:31], s51 offen nt lds
    s_waitcnt vmcnt(5)
    s_barrier
    s_mov_b32 s87, s86
    s_mov_b32 s26, 1
    s_waitcnt lgkmcnt(0)
    s_cmp_eq_u64 s[72:73], s[86:87]
    s_cbranch_scc0 x_spin
    s_cmp_eq_u64 s[74:75], s[86:87]
    s_cbranch_scc0 x_spin
    s_cmp_eq_u64 s[76:77], s[86:87]
    s_cbranch_scc0 x_spin
    s_cmp_eq_u64 s[78:79], s[86:87]
    s_cbranch_scc0 x_spin
x_back:
    v_mov_b32 v4, s14
    v_mov_b32 v5, s15
    v_mov_b32 v6, s26
    v_mov_b32 v3, 134208
    ds_write_b96 v3, v[4:6]
    s_lshl_b32 s49, s27, 19
    s_add_u32 s60, s40, s49
    s_addc_u32 s61, s41, 0
    s_mov_b32 s62, 524288
    s_mov_b32 s63, 0x20000
    s_lshl_b32 s49, s43, 21
    s_and_b32 s50, s44, 7
    s_lshl_b32 s54, s50, 8
    s_add_u32 s49, s49, s54
    s_add_u32 s56, s24, s49
    s_addc_u32 s57, s25, 0
    s_mov_b32 s58, 2095360
    s_mov_b32 s59, 0x20000
    s_waitcnt lgkmcnt(0)
    s_barrier
    v_and_b32 v1, 31, v0
    v_lshrrev_b32 v2, 5, v0
    v_and_b32 v3, 15, v0
    v_xor_b32 v3, v3, v2
    v_lshlrev_b32 v3, 4, v3
    v_lshl_add_u32 v8, v1, 8, v3
    v_xor_b32 v9, 32, v8
    v_xor_b32 v10, 64, v8
    v_xor_b32 v11, 96, v8
    v_xor_b32 v12, 128, v8
    v_xor_b32 v13, 160, v8
    v_xor_b32 v14, 192, v8
    v_xor_b32 v15, 224, v8
    v_bfe_u32 v3, v0, 2, 2
    v_lshl_add_u32 v5, v2, 2, v3
    v_lshlrev_b32 v5, 8, v5
    v_lshl_add_u32 v5, v3, 6, v5
    v_bfe_u32 v6, v0, 4, 1
    v_lshl_add_u32 v5, v6, 5, v5
    v_and_b32 v6, 3, v0
    v_lshl_add_u32 v5, v6, 3, v5
    v_add_u32 v16, 0x8000, v5
    v_xor_b32 v17, 64, v16
    v_xor_b32 v18, 128, v16
    v_xor_b32 v19, 192, v16
    v_pk_mov_b32 v[32:33], 0, 0
    v_pk_mov_b32 v[34:35], 0, 0
    v_pk_mov_b32 v[36:37], 0, 0
    v_pk_mov_b32 v[38:39], 0, 0
    v_pk_mov_b32 v[40:41], 0, 0
    v_pk_mov_b32 v[42:43], 0, 0
    v_pk_mov_b32 v[44:45], 0, 0
    v_pk_mov_b32 v[46:47], 0, 0
    v_pk_mov_b32 v[48:49], 0, 0
    v_pk_mov_b32 v[50:51], 0, 0
    v_pk_mov_b32 v[52:53], 0, 0
    v_pk_mov_b32 v[54:55], 0, 0
    v_pk_mov_b32 v[56:57], 0, 0
    v_pk_mov_b32 v[58:59], 0, 0
    v_pk_mov_b32 v[60:61], 0, 0
    v_pk_mov_b32 v[62:63], 0, 0
    v_pk_mov_b32 v[64:65], 0, 0
    v_pk_mov_b32 v[66:67], 0, 0
    v_pk_mov_b32 v[68:69], 0, 0
    v_pk_mov_b32 v[70:71], 0, 0
    v_pk_mov_b32 v[72:73], 0, 0
    v_pk_mov_b32 v[74:75], 0, 0
    v_pk_mov_b32 v[76:77], 0, 0
    v_pk_mov_b32 v[78:79], 0, 0
    v_pk_mov_b32 v[80:81], 0, 0
    v_pk_mov_b32 v[82:83], 0, 0
    v_pk_mov_b32 v[84:85], 0, 0
    v_pk_mov_b32 v[86:87], 0, 0
    v_pk_mov_b32 v[88:89], 0, 0
    v_pk_mov_b32 v[90:91], 0, 0
    v_pk_mov_b32 v[92:93], 0, 0
    v_pk_mov_b32 v[94:95], 0, 0
    v_mov_b32 v30, 0
    v_pk_mov_b32 v[96:97], 0, 0
    v_pk_mov_b32 v[98:99], 0, 0
    v_pk_mov_b32 v[100:101], 0, 0
    v_pk_mov_b32 v[102:103], 0, 0
    v_pk_mov_b32 v[104:105], 0, 0
    v_pk_mov_b32 v[106:107], 0, 0
    v_pk_mov_b32 v[108:109], 0, 0
    v_pk_mov_b32 v[110:111], 0, 0
    s_and_b32 s50, s7, 2
    s_lshl_b32 s50, s50, 1
    s_and_b32 s49, s7, 1
    s_lshl_b32 s49, s49, 3
    s_add_u32 s49, s49, s50
    v_bfe_u32 v3, v0, 1, 2
    v_bfe_u32 v4, v0, 3, 2
    v_lshl_add_u32 v3, v4, 4, v3
    v_add_u32 v3, s49, v3
    v_and_b32 v4, 1, v0
    v_lshlrev_b32 v4, 7, v4
    v_lshl_add_u32 v28, v3, 11, v4
    s_lshl_b32 s49, s7, 12
    s_add_u32 s49, s49, 131072
    v_add_u32 v3, s49, v27
    ds_write_b128 v3, v[96:99]
    ds_write_b128 v3, v[96:99] offset:1024
    v_lshrrev_b32 v4, 4, v1
    v_lshl_add_u32 v3, v4, 10, v3
    v_bfe_u32 v4, v1, 3, 1
    v_lshl_add_u32 v3, v4, 3, v3
    v_bfe_u32 v4, v1, 1, 1
    v_lshl_add_u32 v3, v4, 2, v3
    v_and_b32 v4, 1, v1
    v_lshlrev_b32 v4, 4, v4
    v_mov_b32 v5, 0x3f80
    v_lshlrev_b32 v4, v4, v5
    v_bfe_u32 v5, v1, 2, 1
    v_cmp_eq_u32 vcc, v5, v2
    s_nop 1
    v_cndmask_b32 v4, 0, v4, vcc
    ds_write_b32 v3, v4
    s_xor_b32 s53, s46, 1
    s_lshl_b32 s53, s53, 2
    s_add_u32 s53, s53, s7
    s_lshl_b32 s53, s53, 3
    s_and_b32 s52, s45, 3
    s_add_u32 s52, s52, s53
    s_lshl_b32 s20, s52, 12
    s_add_u32 s21, s20, 16384
    s_lshl_b32 s54, s27, 19
    s_add_u32 s19, s54, 262144
    s_and_b32 s51, s44, 7
    s_lshl_b32 s51, s51, 2
    s_add_u32 s51, s51, s7
    s_lshl_b32 s49, s51, 3
    s_add_u32 s49, s49, s54
    s_add_u32 s16, s49, 270336
    s_xor_b32 s17, s16, 32
    s_lshl_b32 s49, s51, 8
    s_add_u32 s22, s49, 278528
    s_xor_b32 s23, s22, 1024
    s_mul_i32 s24, s46, 98304
    s_add_u32 s24, s24, s9
    s_mov_b32 s18, 0
    s_mov_b32 s25, 3
    v_mov_b32 v4, s14
    v_mov_b32 v5, s15
    v_mov_b32 v6, 0
    s_barrier
    ds_read_b128 v[176:179], v8 offset:0
    ds_read_b128 v[180:183], v9 offset:0
    ds_read_b128 v[184:187], v10 offset:0
    ds_read_b128 v[188:191], v11 offset:0
    ds_read_b128 v[192:195], v12 offset:0
    ds_read_b128 v[196:199], v13 offset:0
    ds_read_b128 v[200:203], v14 offset:0
    ds_read_b128 v[204:207], v15 offset:0
    s_barrier
    s_cmp_eq_u32 s26, 0
    s_cbranch_scc1 h_acq_s
h_acq_d:
    buffer_load_dwordx4 v[112:115], v27, s[60:63], s20 offen offset:0 sc1
    buffer_load_dwordx4 v[116:119], v27, s[60:63], s20 offen offset:1024 sc1
    buffer_load_dwordx4 v[120:123], v27, s[60:63], s20 offen offset:2048 sc1
    buffer_load_dwordx4 v[124:127], v27, s[60:63], s20 offen offset:3072 sc1
    buffer_load_dwordx4 v[128:131], v27, s[60:63], s21 offen offset:0 sc1
    buffer_load_dwordx4 v[132:135], v27, s[60:63], s21 offen offset:1024 sc1
    buffer_load_dwordx4 v[136:139], v27, s[60:63], s21 offen offset:2048 sc1
    buffer_load_dwordx4 v[140:143], v27, s[60:63], s21 offen offset:3072 sc1
    s_setprio 1
    s_waitcnt vmcnt(8)
    s_barrier
    s_waitcnt lgkmcnt(0)
    s_mov_b32 s53, 0
    s_waitcnt vmcnt(0)
    v_mfma_f32_32x32x16_bf16 v[144:159], v[176:179], v[112:115], v[96:111]
    s_add_u32 s5, s9, 16384
    s_add_u32 m0, s8, 49152
    s_and_b32 s5, s5, 0x3ffff
    buffer_load_dwordx4 v21, s[28:31], s5 offen nt lds
    v_mfma_f32_32x32x16_bf16 v[144:159], v[180:183], v[116:119], v[144:159]
    ds_read_b128 v[176:179], v8 offset:8192
    s_add_u32 m0, s8, 53248
    s_add_u32 s5, s5, 4096
    buffer_load_dwordx4 v21, s[28:31], s5 offen nt lds
    v_mfma_f32_32x32x16_bf16 v[144:159], v[184:187], v[120:123], v[144:159]
    ds_read_b128 v[180:183], v9 offset:8192
    s_add_u32 m0, s8, 57344
    s_add_u32 s5, s5, 4096
    buffer_load_dwordx4 v21, s[28:31], s5 offen nt lds
    v_mfma_f32_32x32x16_bf16 v[144:159], v[188:191], v[124:127], v[144:159]
    ds_read_b128 v[184:187], v10 offset:8192
    s_add_u32 m0, s8, 61440
    s_add_u32 s5, s5, 4096
    buffer_load_dwordx4 v21, s[28:31], s5 offen nt lds
    v_mfma_f32_32x32x16_bf16 v[144:159], v[192:195], v[128:131], v[144:159]
    ds_read_b128 v[188:191], v11 offset:8192
    s_add_u32 s4, s9, 32768
    s_add_u32 m0, s8, 65536
    s_and_b32 s4, s4, 0x3ffff
    buffer_load_dwordx4 v20, s[68:71], s4 offen nt lds
    v_mfma_f32_32x32x16_bf16 v[144:159], v[196:199], v[132:135], v[144:159]
    ds_read_b128 v[192:195], v12 offset:8192
    s_add_u32 m0, s8, 69632
    s_add_u32 s4, s4, 4096
    buffer_load_dwordx4 v20, s[68:71], s4 offen nt lds
    v_mfma_f32_32x32x16_bf16 v[144:159], v[200:203], v[136:139], v[144:159]
    ds_read_b128 v[196:199], v13 offset:8192
    s_add_u32 m0, s8, 73728
    s_add_u32 s4, s4, 4096
    buffer_load_dwordx4 v20, s[68:71], s4 offen nt lds
    v_mfma_f32_32x32x16_bf16 v[144:159], v[204:207], v[140:143], v[144:159]
    ds_read_b128 v[200:203], v14 offset:8192
    s_add_u32 m0, s8, 77824
    s_add_u32 s4, s4, 4096
    buffer_load_dwordx4 v20, s[68:71], s4 offen nt lds
    ds_read_b128 v[204:207], v15 offset:8192
    s_nop 7
    s_nop 2
    v_exp_f32 v144, v144
    v_exp_f32 v145, v145
    v_exp_f32 v146, v146
    v_exp_f32 v147, v147
    v_exp_f32 v148, v148
    v_exp_f32 v149, v149
    v_add_f32 v30, v30, v144
    v_add_f32 v30, v30, v145
    v_cvt_pk_bf16_f32 v240, v144, v145
    v_add_f32 v30, v30, v146
    v_add_f32 v30, v30, v147
    v_cvt_pk_bf16_f32 v241, v146, v147
    v_add_f32 v30, v30, v148
    s_waitcnt lgkmcnt(0)
h_loop:
    v_mfma_f32_32x32x16_bf16 v[160:175], v[176:179], v[112:115], v[96:111]
    ds_read_b64_tr_b16 v[208:209], v16 offset:0
    ds_read_b64_tr_b16 v[210:211], v16 offset:2048
    v_exp_f32 v150, v150
    v_add_f32 v30, v30, v149
    v_cvt_pk_bf16_f32 v242, v148, v149
    s_add_u32 s5, s9, 32768
    s_add_u32 m0, s8, 98304
    s_and_b32 s5, s5, 0x3ffff
    buffer_load_dwordx4 v21, s[28:31], s5 offen nt lds
    v_mfma_f32_32x32x16_bf16 v[160:175], v[180:183], v[116:119], v[160:175]
    ds_read_b64_tr_b16 v[212:213], v17 offset:0
    ds_read_b64_tr_b16 v[214:215], v17 offset:2048
    v_exp_f32 v151, v151
    v_add_f32 v30, v30, v150
    s_add_u32 m0, s8, 102400
    s_add_u32 s5, s5, 4096
    buffer_load_dwordx4 v21, s[28:31], s5 offen nt lds
    v_mfma_f32_32x32x16_bf16 v[160:175], v[184:187], v[120:123], v[160:175]
    ds_read_b64_tr_b16 v[216:217], v18 offset:0
    ds_read_b64_tr_b16 v[218:219], v18 offset:2048
    v_exp_f32 v152, v152
    v_add_f32 v30, v30, v151
    v_cvt_pk_bf16_f32 v243, v150, v151
    s_add_u32 m0, s8, 106496
    s_add_u32 s5, s5, 4096
    buffer_load_dwordx4 v21, s[28:31], s5 offen nt lds
    v_mfma_f32_32x32x16_bf16 v[160:175], v[188:191], v[124:127], v[160:175]
    ds_read_b64_tr_b16 v[220:221], v19 offset:0
    ds_read_b64_tr_b16 v[222:223], v19 offset:2048
    v_exp_f32 v153, v153
    v_add_f32 v30, v30, v152
    s_add_u32 m0, s8, 110592
    s_add_u32 s5, s5, 4096
    buffer_load_dwordx4 v21, s[28:31], s5 offen nt lds
    v_mfma_f32_32x32x16_bf16 v[160:175], v[192:195], v[128:131], v[160:175]
    ds_read_b64_tr_b16 v[224:225], v16 offset:4096
    ds_read_b64_tr_b16 v[226:227], v16 offset:6144
    v_exp_f32 v154, v154
    v_add_f32 v30, v30, v153
    v_cvt_pk_bf16_f32 v244, v152, v153
    v_mfma_f32_32x32x16_bf16 v[160:175], v[196:199], v[132:135], v[160:175]
    ds_read_b64_tr_b16 v[228:229], v17 offset:4096
    ds_read_b64_tr_b16 v[230:231], v17 offset:6144
    v_exp_f32 v155, v155
    v_add_f32 v30, v30, v154
    v_mfma_f32_32x32x16_bf16 v[160:175], v[200:203], v[136:139], v[160:175]
    ds_read_b64_tr_b16 v[232:233], v18 offset:4096
    ds_read_b64_tr_b16 v[234:235], v18 offset:6144
    v_exp_f32 v156, v156
    v_add_f32 v30, v30, v155
    v_cvt_pk_bf16_f32 v245, v154, v155
    v_mfma_f32_32x32x16_bf16 v[160:175], v[204:207], v[140:143], v[160:175]
    s_waitcnt lgkmcnt(6)
    ds_read_b64_tr_b16 v[236:237], v19 offset:4096
    ds_read_b64_tr_b16 v[238:239], v19 offset:6144
    v_exp_f32 v157, v157
    v_add_f32 v30, v30, v156
    v_mfma_f32_32x32x16_bf16 v[32:47], v[208:211], v[240:243], v[32:47]
    ds_read_b128 v[176:179], v8 offset:16384
    ds_read_b128 v[180:183], v9 offset:16384
    v_exp_f32 v158, v158
    v_add_f32 v30, v30, v157
    v_cvt_pk_bf16_f32 v246, v156, v157
    v_mfma_f32_32x32x16_bf16 v[48:63], v[212:215], v[240:243], v[48:63]
    ds_read_b128 v[184:187], v10 offset:16384
    ds_read_b128 v[188:191], v11 offset:16384
    v_exp_f32 v159, v159
    v_add_f32 v30, v30, v158
    v_mfma_f32_32x32x16_bf16 v[64:79], v[216:219], v[240:243], v[64:79]
    ds_read_b128 v[192:195], v12 offset:16384
    ds_read_b128 v[196:199], v13 offset:16384
    v_exp_f32 v160, v160
    v_add_f32 v30, v30, v159
    v_cvt_pk_bf16_f32 v247, v158, v159
    v_mfma_f32_32x32x16_bf16 v[80:95], v[220:223], v[240:243], v[80:95]
    s_waitcnt lgkmcnt(6)
    ds_read_b128 v[200:203], v14 offset:16384
    ds_read_b128 v[204:207], v15 offset:16384
    v_exp_f32 v161, v161
    v_add_f32 v30, v30, v160
    v_mfma_f32_32x32x16_bf16 v[32:47], v[224:227], v[244:247], v[32:47]
    v_exp_f32 v162, v162
    v_add_f32 v30, v30, v161
    v_cvt_pk_bf16_f32 v240, v160, v161
    v_mfma_f32_32x32x16_bf16 v[48:63], v[228:231], v[244:247], v[48:63]
    v_exp_f32 v163, v163
    v_add_f32 v30, v30, v162
    v_mfma_f32_32x32x16_bf16 v[64:79], v[232:235], v[244:247], v[64:79]
    v_exp_f32 v164, v164
    v_add_f32 v30, v30, v163
    v_cvt_pk_bf16_f32 v241, v162, v163
    v_mfma_f32_32x32x16_bf16 v[80:95], v[236:239], v[244:247], v[80:95]
    s_waitcnt lgkmcnt(0)
    v_exp_f32 v165, v165
    v_add_f32 v30, v30, v164
    v_mfma_f32_32x32x16_bf16 v[144:159], v[176:179], v[112:115], v[96:111]
    ds_read_b64_tr_b16 v[208:209], v16 offset:8192
    ds_read_b64_tr_b16 v[210:211], v16 offset:10240
    v_exp_f32 v166, v166
    v_add_f32 v30, v30, v165
    v_cvt_pk_bf16_f32 v242, v164, v165
    s_add_u32 s4, s9, 49152
    s_add_u32 m0, s8, 81920
    s_and_b32 s4, s4, 0x3ffff
    buffer_load_dwordx4 v20, s[68:71], s4 offen nt lds
    v_mfma_f32_32x32x16_bf16 v[144:159], v[180:183], v[116:119], v[144:159]
    ds_read_b64_tr_b16 v[212:213], v17 offset:8192
    ds_read_b64_tr_b16 v[214:215], v17 offset:10240
    v_exp_f32 v167, v167
    v_add_f32 v30, v30, v166
    s_add_u32 m0, s8, 86016
    s_add_u32 s4, s4, 4096
    buffer_load_dwordx4 v20, s[68:71], s4 offen nt lds
    v_mfma_f32_32x32x16_bf16 v[144:159], v[184:187], v[120:123], v[144:159]
    ds_read_b64_tr_b16 v[216:217], v18 offset:8192
    ds_read_b64_tr_b16 v[218:219], v18 offset:10240
    v_exp_f32 v168, v168
    v_add_f32 v30, v30, v167
    v_cvt_pk_bf16_f32 v243, v166, v167
    s_add_u32 m0, s8, 90112
    s_add_u32 s4, s4, 4096
    buffer_load_dwordx4 v20, s[68:71], s4 offen nt lds
    v_mfma_f32_32x32x16_bf16 v[144:159], v[188:191], v[124:127], v[144:159]
    ds_read_b64_tr_b16 v[220:221], v19 offset:8192
    ds_read_b64_tr_b16 v[222:223], v19 offset:10240
    v_exp_f32 v169, v169
    v_add_f32 v30, v30, v168
    s_add_u32 m0, s8, 94208
    s_add_u32 s4, s4, 4096
    buffer_load_dwordx4 v20, s[68:71], s4 offen nt lds
    v_mfma_f32_32x32x16_bf16 v[144:159], v[192:195], v[128:131], v[144:159]
    ds_read_b64_tr_b16 v[224:225], v16 offset:12288
    ds_read_b64_tr_b16 v[226:227], v16 offset:14336
    v_exp_f32 v170, v170
    v_add_f32 v30, v30, v169
    v_cvt_pk_bf16_f32 v244, v168, v169
    v_mfma_f32_32x32x16_bf16 v[144:159], v[196:199], v[132:135], v[144:159]
    ds_read_b64_tr_b16 v[228:229], v17 offset:12288
    ds_read_b64_tr_b16 v[230:231], v17 offset:14336
    v_exp_f32 v171, v171
    v_add_f32 v30, v30, v170
    v_mfma_f32_32x32x16_bf16 v[144:159], v[200:203], v[136:139], v[144:159]
    ds_read_b64_tr_b16 v[232:233], v18 offset:12288
    ds_read_b64_tr_b16 v[234:235], v18 offset:14336
    v_exp_f32 v172, v172
    v_add_f32 v30, v30, v171
    v_cvt_pk_bf16_f32 v245, v170, v171
    v_mfma_f32_32x32x16_bf16 v[144:159], v[204:207], v[140:143], v[144:159]
    s_waitcnt lgkmcnt(6)
    ds_read_b64_tr_b16 v[236:237], v19 offset:12288
    ds_read_b64_tr_b16 v[238:239], v19 offset:14336
    v_exp_f32 v173, v173
    v_add_f32 v30, v30, v172
    v_mfma_f32_32x32x16_bf16 v[32:47], v[208:211], v[240:243], v[32:47]
    ds_read_b128 v[176:179], v8 offset:24576
    ds_read_b128 v[180:183], v9 offset:24576
    v_exp_f32 v174, v174
    v_add_f32 v30, v30, v173
    v_cvt_pk_bf16_f32 v246, v172, v173
    v_mfma_f32_32x32x16_bf16 v[48:63], v[212:215], v[240:243], v[48:63]
    ds_read_b128 v[184:187], v10 offset:24576
    ds_read_b128 v[188:191], v11 offset:24576
    v_exp_f32 v175, v175
    v_add_f32 v30, v30, v174
    v_mfma_f32_32x32x16_bf16 v[64:79], v[216:219], v[240:243], v[64:79]
    ds_read_b128 v[192:195], v12 offset:24576
    ds_read_b128 v[196:199], v13 offset:24576
    v_exp_f32 v144, v144
    v_add_f32 v30, v30, v175
    v_cvt_pk_bf16_f32 v247, v174, v175
    v_mfma_f32_32x32x16_bf16 v[80:95], v[220:223], v[240:243], v[80:95]
    s_waitcnt lgkmcnt(6)
    ds_read_b128 v[200:203], v14 offset:24576
    ds_read_b128 v[204:207], v15 offset:24576
    v_exp_f32 v145, v145
    v_add_f32 v30, v30, v144
    v_mfma_f32_32x32x16_bf16 v[32:47], v[224:227], v[244:247], v[32:47]
    v_exp_f32 v146, v146
    v_add_f32 v30, v30, v145
    v_cvt_pk_bf16_f32 v240, v144, v145
    v_xor_b32 v8, 0x10000, v8
    v_mfma_f32_32x32x16_bf16 v[48:63], v[228:231], v[244:247], v[48:63]
    v_exp_f32 v147, v147
    v_add_f32 v30, v30, v146
    v_xor_b32 v10, 0x10000, v10
    v_mfma_f32_32x32x16_bf16 v[64:79], v[232:235], v[244:247], v[64:79]
    v_exp_f32 v148, v148
    v_add_f32 v30, v30, v147
    v_cvt_pk_bf16_f32 v241, v146, v147
    v_xor_b32 v12, 0x10000, v12
    v_mfma_f32_32x32x16_bf16 v[80:95], v[236:239], v[244:247], v[80:95]
    s_waitcnt lgkmcnt(0)
    v_exp_f32 v149, v149
    v_add_f32 v30, v30, v148
    v_xor_b32 v14, 0x10000, v14
    v_mfma_f32_32x32x16_bf16 v[160:175], v[176:179], v[112:115], v[96:111]
    s_waitcnt vmcnt(8)
    s_barrier
    ds_read_b64_tr_b16 v[208:209], v16 offset:16384
    ds_read_b64_tr_b16 v[210:211], v16 offset:18432
    v_exp_f32 v150, v150
    v_add_f32 v30, v30, v149
    v_cvt_pk_bf16_f32 v242, v148, v149
    s_add_u32 s5, s9, 49152
    s_add_u32 m0, s8, 114688
    s_and_b32 s5, s5, 0x3ffff
    buffer_load_dwordx4 v21, s[28:31], s5 offen nt lds
    v_mfma_f32_32x32x16_bf16 v[160:175], v[180:183], v[116:119], v[160:175]
    ds_read_b64_tr_b16 v[212:213], v17 offset:16384
    ds_read_b64_tr_b16 v[214:215], v17 offset:18432
    v_exp_f32 v151, v151
    v_add_f32 v30, v30, v150
    v_xor_b32 v9, 0x10000, v9
    s_add_u32 m0, s8, 118784
    s_add_u32 s5, s5, 4096
    buffer_load_dwordx4 v21, s[28:31], s5 offen nt lds
    v_mfma_f32_32x32x16_bf16 v[160:175], v[184:187], v[120:123], v[160:175]
    ds_read_b64_tr_b16 v[216:217], v18 offset:16384
    ds_read_b64_tr_b16 v[218:219], v18 offset:18432
    v_exp_f32 v152, v152
    v_add_f32 v30, v30, v151
    v_cvt_pk_bf16_f32 v243, v150, v151
    s_add_u32 m0, s8, 122880
    s_add_u32 s5, s5, 4096
    buffer_load_dwordx4 v21, s[28:31], s5 offen nt lds
    v_mfma_f32_32x32x16_bf16 v[160:175], v[188:191], v[124:127], v[160:175]
    ds_read_b64_tr_b16 v[220:221], v19 offset:16384
    ds_read_b64_tr_b16 v[222:223], v19 offset:18432
    v_exp_f32 v153, v153
    v_add_f32 v30, v30, v152
    v_xor_b32 v11, 0x10000, v11
    s_add_u32 m0, s8, 126976
    s_add_u32 s5, s5, 4096
    buffer_load_dwordx4 v21, s[28:31], s5 offen nt lds
    v_mfma_f32_32x32x16_bf16 v[160:175], v[192:195], v[128:131], v[160:175]
    ds_read_b64_tr_b16 v[224:225], v16 offset:20480
    ds_read_b64_tr_b16 v[226:227], v16 offset:22528
    v_exp_f32 v154, v154
    v_add_f32 v30, v30, v153
    v_cvt_pk_bf16_f32 v244, v152, v153
    v_mfma_f32_32x32x16_bf16 v[160:175], v[196:199], v[132:135], v[160:175]
    ds_read_b64_tr_b16 v[228:229], v17 offset:20480
    ds_read_b64_tr_b16 v[230:231], v17 offset:22528
    v_exp_f32 v155, v155
    v_add_f32 v30, v30, v154
    v_xor_b32 v13, 0x10000, v13
    v_mfma_f32_32x32x16_bf16 v[160:175], v[200:203], v[136:139], v[160:175]
    ds_read_b64_tr_b16 v[232:233], v18 offset:20480
    ds_read_b64_tr_b16 v[234:235], v18 offset:22528
    v_exp_f32 v156, v156
    v_add_f32 v30, v30, v155
    v_cvt_pk_bf16_f32 v245, v154, v155
    v_mfma_f32_32x32x16_bf16 v[160:175], v[204:207], v[140:143], v[160:175]
    s_waitcnt lgkmcnt(6)
    ds_read_b64_tr_b16 v[236:237], v19 offset:20480
    ds_read_b64_tr_b16 v[238:239], v19 offset:22528
    v_exp_f32 v157, v157
    v_add_f32 v30, v30, v156
    v_xor_b32 v15, 0x10000, v15
    v_mfma_f32_32x32x16_bf16 v[32:47], v[208:211], v[240:243], v[32:47]
    ds_read_b128 v[176:179], v8 offset:0
    ds_read_b128 v[180:183], v9 offset:0
    v_exp_f32 v158, v158
    v_add_f32 v30, v30, v157
    v_cvt_pk_bf16_f32 v246, v156, v157
    v_mfma_f32_32x32x16_bf16 v[48:63], v[212:215], v[240:243], v[48:63]
    ds_read_b128 v[184:187], v10 offset:0
    ds_read_b128 v[188:191], v11 offset:0
    v_exp_f32 v159, v159
    v_add_f32 v30, v30, v158
    v_mfma_f32_32x32x16_bf16 v[64:79], v[216:219], v[240:243], v[64:79]
    ds_read_b128 v[192:195], v12 offset:0
    ds_read_b128 v[196:199], v13 offset:0
    v_exp_f32 v160, v160
    v_add_f32 v30, v30, v159
    v_cvt_pk_bf16_f32 v247, v158, v159
    v_mfma_f32_32x32x16_bf16 v[80:95], v[220:223], v[240:243], v[80:95]
    s_waitcnt lgkmcnt(6)
    ds_read_b128 v[200:203], v14 offset:0
    ds_read_b128 v[204:207], v15 offset:0
    v_exp_f32 v161, v161
    v_add_f32 v30, v30, v160
    v_mfma_f32_32x32x16_bf16 v[32:47], v[224:227], v[244:247], v[32:47]
    v_exp_f32 v162, v162
    v_add_f32 v30, v30, v161
    v_cvt_pk_bf16_f32 v240, v160, v161
    v_mfma_f32_32x32x16_bf16 v[48:63], v[228:231], v[244:247], v[48:63]
    v_exp_f32 v163, v163
    v_add_f32 v30, v30, v162
    v_mfma_f32_32x32x16_bf16 v[64:79], v[232:235], v[244:247], v[64:79]
    v_exp_f32 v164, v164
    v_add_f32 v30, v30, v163
    v_cvt_pk_bf16_f32 v241, v162, v163
    v_mfma_f32_32x32x16_bf16 v[80:95], v[236:239], v[244:247], v[80:95]
    s_waitcnt lgkmcnt(0)
    v_exp_f32 v165, v165
    v_add_f32 v30, v30, v164
    v_mfma_f32_32x32x16_bf16 v[144:159], v[176:179], v[112:115], v[96:111]
    ds_read_b64_tr_b16 v[208:209], v16 offset:24576
    ds_read_b64_tr_b16 v[210:211], v16 offset:26624
    v_exp_f32 v166, v166
    v_add_f32 v30, v30, v165
    v_cvt_pk_bf16_f32 v242, v164, v165
    s_mov_b64 exec, 1
    buffer_store_dwordx2 v[4:5], v6, s[64:67], s16 offen sc1
    s_mov_b64 exec, -1
    v_mfma_f32_32x32x16_bf16 v[144:159], v[180:183], v[116:119], v[144:159]
    ds_read_b64_tr_b16 v[212:213], v17 offset:24576
    ds_read_b64_tr_b16 v[214:215], v17 offset:26624
    v_exp_f32 v167, v167
    v_add_f32 v30, v30, v166
    s_add_u32 s4, s9, 65536
    s_add_u32 m0, s8, 0
    s_and_b32 s4, s4, 0x3ffff
    buffer_load_dwordx4 v20, s[68:71], s4 offen nt lds
    v_mfma_f32_32x32x16_bf16 v[144:159], v[184:187], v[120:123], v[144:159]
    ds_read_b64_tr_b16 v[216:217], v18 offset:24576
    ds_read_b64_tr_b16 v[218:219], v18 offset:26624
    v_exp_f32 v168, v168
    v_add_f32 v30, v30, v167
    v_cvt_pk_bf16_f32 v243, v166, v167
    s_add_u32 m0, s8, 4096
    s_add_u32 s4, s4, 4096
    buffer_load_dwordx4 v20, s[68:71], s4 offen nt lds
    v_mfma_f32_32x32x16_bf16 v[144:159], v[188:191], v[124:127], v[144:159]
    ds_read_b64_tr_b16 v[220:221], v19 offset:24576
    ds_read_b64_tr_b16 v[222:223], v19 offset:26624
    v_exp_f32 v169, v169
    v_add_f32 v30, v30, v168
    s_add_u32 m0, s8, 8192
    s_add_u32 s4, s4, 4096
    buffer_load_dwordx4 v20, s[68:71], s4 offen nt lds
    v_mfma_f32_32x32x16_bf16 v[144:159], v[192:195], v[128:131], v[144:159]
    ds_read_b64_tr_b16 v[224:225], v16 offset:28672
    ds_read_b64_tr_b16 v[226:227], v16 offset:30720
    v_exp_f32 v170, v170
    v_add_f32 v30, v30, v169
    v_cvt_pk_bf16_f32 v244, v168, v169
    s_add_u32 m0, s8, 12288
    s_add_u32 s4, s4, 4096
    buffer_load_dwordx4 v20, s[68:71], s4 offen nt lds
    v_mfma_f32_32x32x16_bf16 v[144:159], v[196:199], v[132:135], v[144:159]
    ds_read_b64_tr_b16 v[228:229], v17 offset:28672
    ds_read_b64_tr_b16 v[230:231], v17 offset:30720
    v_exp_f32 v171, v171
    v_add_f32 v30, v30, v170
    v_mfma_f32_32x32x16_bf16 v[144:159], v[200:203], v[136:139], v[144:159]
    ds_read_b64_tr_b16 v[232:233], v18 offset:28672
    ds_read_b64_tr_b16 v[234:235], v18 offset:30720
    v_exp_f32 v172, v172
    v_add_f32 v30, v30, v171
    v_cvt_pk_bf16_f32 v245, v170, v171
    v_mfma_f32_32x32x16_bf16 v[144:159], v[204:207], v[140:143], v[144:159]
    s_waitcnt lgkmcnt(6)
    ds_read_b64_tr_b16 v[236:237], v19 offset:28672
    ds_read_b64_tr_b16 v[238:239], v19 offset:30720
    v_exp_f32 v173, v173
    v_add_f32 v30, v30, v172
    v_mfma_f32_32x32x16_bf16 v[32:47], v[208:211], v[240:243], v[32:47]
    ds_read_b128 v[176:179], v8 offset:8192
    ds_read_b128 v[180:183], v9 offset:8192
    v_exp_f32 v174, v174
    v_add_f32 v30, v30, v173
    v_cvt_pk_bf16_f32 v246, v172, v173
    v_mfma_f32_32x32x16_bf16 v[48:63], v[212:215], v[240:243], v[48:63]
    ds_read_b128 v[184:187], v10 offset:8192
    ds_read_b128 v[188:191], v11 offset:8192
    v_exp_f32 v175, v175
    v_add_f32 v30, v30, v174
    v_mfma_f32_32x32x16_bf16 v[64:79], v[216:219], v[240:243], v[64:79]
    ds_read_b128 v[192:195], v12 offset:8192
    ds_read_b128 v[196:199], v13 offset:8192
    v_exp_f32 v144, v144
    v_add_f32 v30, v30, v175
    v_cvt_pk_bf16_f32 v247, v174, v175
    v_mfma_f32_32x32x16_bf16 v[80:95], v[220:223], v[240:243], v[80:95]
    s_waitcnt lgkmcnt(6)
    ds_read_b128 v[200:203], v14 offset:8192
    ds_read_b128 v[204:207], v15 offset:8192
    v_exp_f32 v145, v145
    v_add_f32 v30, v30, v144
    v_mfma_f32_32x32x16_bf16 v[32:47], v[224:227], v[244:247], v[32:47]
    v_exp_f32 v146, v146
    v_add_f32 v30, v30, v145
    v_cvt_pk_bf16_f32 v240, v144, v145
    v_xor_b32 v16, 0x10000, v16
    v_mfma_f32_32x32x16_bf16 v[48:63], v[228:231], v[244:247], v[48:63]
    v_exp_f32 v147, v147
    v_add_f32 v30, v30, v146
    v_xor_b32 v17, 0x10000, v17
    v_mfma_f32_32x32x16_bf16 v[64:79], v[232:235], v[244:247], v[64:79]
    v_exp_f32 v148, v148
    v_add_f32 v30, v30, v147
    v_cvt_pk_bf16_f32 v241, v146, v147
    v_xor_b32 v18, 0x10000, v18
    v_mfma_f32_32x32x16_bf16 v[80:95], v[236:239], v[244:247], v[80:95]
    s_waitcnt lgkmcnt(0)
    v_exp_f32 v149, v149
    v_add_f32 v30, v30, v148
    v_xor_b32 v19, 0x10000, v19
    v_mfma_f32_32x32x16_bf16 v[160:175], v[176:179], v[112:115], v[96:111]
    s_waitcnt vmcnt(9)
    s_barrier
    ds_read_b64_tr_b16 v[208:209], v16 offset:0
    ds_read_b64_tr_b16 v[210:211], v16 offset:2048
    v_exp_f32 v150, v150
    v_add_f32 v30, v30, v149
    v_cvt_pk_bf16_f32 v242, v148, v149
    s_add_u32 s5, s9, 65536
    s_add_u32 m0, s8, 32768
    s_and_b32 s5, s5, 0x3ffff
    buffer_load_dwordx4 v21, s[28:31], s5 offen nt lds
    v_mfma_f32_32x32x16_bf16 v[160:175], v[180:183], v[116:119], v[160:175]
    ds_read_b64_tr_b16 v[212:213], v17 offset:0
    ds_read_b64_tr_b16 v[214:215], v17 offset:2048
    v_exp_f32 v151, v151
    v_add_f32 v30, v30, v150
    s_add_u32 m0, s8, 36864
    s_add_u32 s5, s5, 4096
    buffer_load_dwordx4 v21, s[28:31], s5 offen nt lds
    v_mfma_f32_32x32x16_bf16 v[160:175], v[184:187], v[120:123], v[160:175]
    ds_read_b64_tr_b16 v[216:217], v18 offset:0
    ds_read_b64_tr_b16 v[218:219], v18 offset:2048
    v_exp_f32 v152, v152
    v_add_f32 v30, v30, v151
    v_cvt_pk_bf16_f32 v243, v150, v151
    s_add_u32 m0, s8, 40960
    s_add_u32 s5, s5, 4096
    buffer_load_dwordx4 v21, s[28:31], s5 offen nt lds
    v_mfma_f32_32x32x16_bf16 v[160:175], v[188:191], v[124:127], v[160:175]
    ds_read_b64_tr_b16 v[220:221], v19 offset:0
    ds_read_b64_tr_b16 v[222:223], v19 offset:2048
    v_exp_f32 v153, v153
    v_add_f32 v30, v30, v152
    s_add_u32 m0, s8, 45056
    s_add_u32 s5, s5, 4096
    buffer_load_dwordx4 v21, s[28:31], s5 offen nt lds
    v_mfma_f32_32x32x16_bf16 v[160:175], v[192:195], v[128:131], v[160:175]
    ds_read_b64_tr_b16 v[224:225], v16 offset:4096
    ds_read_b64_tr_b16 v[226:227], v16 offset:6144
    v_exp_f32 v154, v154
    v_add_f32 v30, v30, v153
    v_cvt_pk_bf16_f32 v244, v152, v153
    v_mfma_f32_32x32x16_bf16 v[160:175], v[196:199], v[132:135], v[160:175]
    ds_read_b64_tr_b16 v[228:229], v17 offset:4096
    ds_read_b64_tr_b16 v[230:231], v17 offset:6144
    v_exp_f32 v155, v155
    v_add_f32 v30, v30, v154
    v_mfma_f32_32x32x16_bf16 v[160:175], v[200:203], v[136:139], v[160:175]
    ds_read_b64_tr_b16 v[232:233], v18 offset:4096
    ds_read_b64_tr_b16 v[234:235], v18 offset:6144
    v_exp_f32 v156, v156
    v_add_f32 v30, v30, v155
    v_cvt_pk_bf16_f32 v245, v154, v155
    v_mfma_f32_32x32x16_bf16 v[160:175], v[204:207], v[140:143], v[160:175]
    s_waitcnt lgkmcnt(6)
    ds_read_b64_tr_b16 v[236:237], v19 offset:4096
    ds_read_b64_tr_b16 v[238:239], v19 offset:6144
    v_exp_f32 v157, v157
    v_add_f32 v30, v30, v156
    v_mfma_f32_32x32x16_bf16 v[32:47], v[208:211], v[240:243], v[32:47]
    ds_read_b128 v[176:179], v8 offset:16384
    ds_read_b128 v[180:183], v9 offset:16384
    v_exp_f32 v158, v158
    v_add_f32 v30, v30, v157
    v_cvt_pk_bf16_f32 v246, v156, v157
    v_mfma_f32_32x32x16_bf16 v[48:63], v[212:215], v[240:243], v[48:63]
    ds_read_b128 v[184:187], v10 offset:16384
    ds_read_b128 v[188:191], v11 offset:16384
    v_exp_f32 v159, v159
    v_add_f32 v30, v30, v158
    v_mfma_f32_32x32x16_bf16 v[64:79], v[216:219], v[240:243], v[64:79]
    ds_read_b128 v[192:195], v12 offset:16384
    ds_read_b128 v[196:199], v13 offset:16384
    v_exp_f32 v160, v160
    v_add_f32 v30, v30, v159
    v_cvt_pk_bf16_f32 v247, v158, v159
    v_mfma_f32_32x32x16_bf16 v[80:95], v[220:223], v[240:243], v[80:95]
    s_waitcnt lgkmcnt(6)
    ds_read_b128 v[200:203], v14 offset:16384
    ds_read_b128 v[204:207], v15 offset:16384
    v_exp_f32 v161, v161
    v_add_f32 v30, v30, v160
    v_mfma_f32_32x32x16_bf16 v[32:47], v[224:227], v[244:247], v[32:47]
    v_exp_f32 v162, v162
    v_add_f32 v30, v30, v161
    v_cvt_pk_bf16_f32 v240, v160, v161
    v_mfma_f32_32x32x16_bf16 v[48:63], v[228:231], v[244:247], v[48:63]
    v_exp_f32 v163, v163
    v_add_f32 v30, v30, v162
    v_mfma_f32_32x32x16_bf16 v[64:79], v[232:235], v[244:247], v[64:79]
    v_exp_f32 v164, v164
    v_add_f32 v30, v30, v163
    v_cvt_pk_bf16_f32 v241, v162, v163
    v_mfma_f32_32x32x16_bf16 v[80:95], v[236:239], v[244:247], v[80:95]
    s_waitcnt lgkmcnt(0)
    v_exp_f32 v165, v165
    v_add_f32 v30, v30, v164
    v_mfma_f32_32x32x16_bf16 v[144:159], v[176:179], v[112:115], v[96:111]
    ds_read_b64_tr_b16 v[208:209], v16 offset:8192
    ds_read_b64_tr_b16 v[210:211], v16 offset:10240
    v_exp_f32 v166, v166
    v_add_f32 v30, v30, v165
    v_cvt_pk_bf16_f32 v242, v164, v165
    s_add_u32 s4, s9, 81920
    s_add_u32 m0, s8, 16384
    s_and_b32 s4, s4, 0x3ffff
    buffer_load_dwordx4 v20, s[68:71], s4 offen nt lds
    v_mfma_f32_32x32x16_bf16 v[144:159], v[180:183], v[116:119], v[144:159]
    ds_read_b64_tr_b16 v[212:213], v17 offset:8192
    ds_read_b64_tr_b16 v[214:215], v17 offset:10240
    v_exp_f32 v167, v167
    v_add_f32 v30, v30, v166
    s_add_u32 m0, s8, 20480
    s_add_u32 s4, s4, 4096
    buffer_load_dwordx4 v20, s[68:71], s4 offen nt lds
    v_mfma_f32_32x32x16_bf16 v[144:159], v[184:187], v[120:123], v[144:159]
    ds_read_b64_tr_b16 v[216:217], v18 offset:8192
    ds_read_b64_tr_b16 v[218:219], v18 offset:10240
    v_exp_f32 v168, v168
    v_add_f32 v30, v30, v167
    v_cvt_pk_bf16_f32 v243, v166, v167
    s_add_u32 m0, s8, 24576
    s_add_u32 s4, s4, 4096
    buffer_load_dwordx4 v20, s[68:71], s4 offen nt lds
    v_mfma_f32_32x32x16_bf16 v[144:159], v[188:191], v[124:127], v[144:159]
    ds_read_b64_tr_b16 v[220:221], v19 offset:8192
    ds_read_b64_tr_b16 v[222:223], v19 offset:10240
    v_exp_f32 v169, v169
    v_add_f32 v30, v30, v168
    s_add_u32 m0, s8, 28672
    s_add_u32 s4, s4, 4096
    buffer_load_dwordx4 v20, s[68:71], s4 offen nt lds
    v_mfma_f32_32x32x16_bf16 v[144:159], v[192:195], v[128:131], v[144:159]
    ds_read_b64_tr_b16 v[224:225], v16 offset:12288
    ds_read_b64_tr_b16 v[226:227], v16 offset:14336
    v_exp_f32 v170, v170
    v_add_f32 v30, v30, v169
    v_cvt_pk_bf16_f32 v244, v168, v169
    v_mfma_f32_32x32x16_bf16 v[144:159], v[196:199], v[132:135], v[144:159]
    ds_read_b64_tr_b16 v[228:229], v17 offset:12288
    ds_read_b64_tr_b16 v[230:231], v17 offset:14336
    v_exp_f32 v171, v171
    v_add_f32 v30, v30, v170
    v_mfma_f32_32x32x16_bf16 v[144:159], v[200:203], v[136:139], v[144:159]
    ds_read_b64_tr_b16 v[232:233], v18 offset:12288
    ds_read_b64_tr_b16 v[234:235], v18 offset:14336
    v_exp_f32 v172, v172
    v_add_f32 v30, v30, v171
    v_cvt_pk_bf16_f32 v245, v170, v171
    v_mfma_f32_32x32x16_bf16 v[144:159], v[204:207], v[140:143], v[144:159]
    s_waitcnt lgkmcnt(6)
    ds_read_b64_tr_b16 v[236:237], v19 offset:12288
    ds_read_b64_tr_b16 v[238:239], v19 offset:14336
    v_exp_f32 v173, v173
    v_add_f32 v30, v30, v172
    v_mfma_f32_32x32x16_bf16 v[32:47], v[208:211], v[240:243], v[32:47]
    ds_read_b128 v[176:179], v8 offset:24576
    ds_read_b128 v[180:183], v9 offset:24576
    v_exp_f32 v174, v174
    v_add_f32 v30, v30, v173
    v_cvt_pk_bf16_f32 v246, v172, v173
    v_mfma_f32_32x32x16_bf16 v[48:63], v[212:215], v[240:243], v[48:63]
    ds_read_b128 v[184:187], v10 offset:24576
    ds_read_b128 v[188:191], v11 offset:24576
    v_exp_f32 v175, v175
    v_add_f32 v30, v30, v174
    v_mfma_f32_32x32x16_bf16 v[64:79], v[216:219], v[240:243], v[64:79]
    ds_read_b128 v[192:195], v12 offset:24576
    ds_read_b128 v[196:199], v13 offset:24576
    v_exp_f32 v144, v144
    v_add_f32 v30, v30, v175
    v_cvt_pk_bf16_f32 v247, v174, v175
    v_mfma_f32_32x32x16_bf16 v[80:95], v[220:223], v[240:243], v[80:95]
    s_waitcnt lgkmcnt(6)
    ds_read_b128 v[200:203], v14 offset:24576
    ds_read_b128 v[204:207], v15 offset:24576
    v_exp_f32 v145, v145
    v_add_f32 v30, v30, v144
    v_mfma_f32_32x32x16_bf16 v[32:47], v[224:227], v[244:247], v[32:47]
    v_exp_f32 v146, v146
    v_add_f32 v30, v30, v145
    v_cvt_pk_bf16_f32 v240, v144, v145
    v_xor_b32 v8, 0x10000, v8
    v_mfma_f32_32x32x16_bf16 v[48:63], v[228:231], v[244:247], v[48:63]
    v_exp_f32 v147, v147
    v_add_f32 v30, v30, v146
    v_xor_b32 v10, 0x10000, v10
    v_mfma_f32_32x32x16_bf16 v[64:79], v[232:235], v[244:247], v[64:79]
    v_exp_f32 v148, v148
    v_add_f32 v30, v30, v147
    v_cvt_pk_bf16_f32 v241, v146, v147
    v_xor_b32 v12, 0x10000, v12
    v_mfma_f32_32x32x16_bf16 v[80:95], v[236:239], v[244:247], v[80:95]
    s_waitcnt lgkmcnt(0)
    v_exp_f32 v149, v149
    v_add_f32 v30, v30, v148
    v_xor_b32 v14, 0x10000, v14
    v_mfma_f32_32x32x16_bf16 v[160:175], v[176:179], v[112:115], v[96:111]
    s_waitcnt vmcnt(8)
    s_barrier
    ds_read_b64_tr_b16 v[208:209], v16 offset:16384
    ds_read_b64_tr_b16 v[210:211], v16 offset:18432
    v_exp_f32 v150, v150
    v_add_f32 v30, v30, v149
    v_cvt_pk_bf16_f32 v242, v148, v149
    s_add_u32 s5, s9, 81920
    s_add_u32 m0, s8, 49152
    s_and_b32 s5, s5, 0x3ffff
    buffer_load_dwordx4 v21, s[28:31], s5 offen nt lds
    v_mfma_f32_32x32x16_bf16 v[160:175], v[180:183], v[116:119], v[160:175]
    ds_read_b64_tr_b16 v[212:213], v17 offset:16384
    ds_read_b64_tr_b16 v[214:215], v17 offset:18432
    v_exp_f32 v151, v151
    v_add_f32 v30, v30, v150
    v_xor_b32 v9, 0x10000, v9
    s_add_u32 m0, s8, 53248
    s_add_u32 s5, s5, 4096
    buffer_load_dwordx4 v21, s[28:31], s5 offen nt lds
    v_mfma_f32_32x32x16_bf16 v[160:175], v[184:187], v[120:123], v[160:175]
    ds_read_b64_tr_b16 v[216:217], v18 offset:16384
    ds_read_b64_tr_b16 v[218:219], v18 offset:18432
    v_exp_f32 v152, v152
    v_add_f32 v30, v30, v151
    v_cvt_pk_bf16_f32 v243, v150, v151
    s_add_u32 m0, s8, 57344
    s_add_u32 s5, s5, 4096
    buffer_load_dwordx4 v21, s[28:31], s5 offen nt lds
    v_mfma_f32_32x32x16_bf16 v[160:175], v[188:191], v[124:127], v[160:175]
    ds_read_b64_tr_b16 v[220:221], v19 offset:16384
    ds_read_b64_tr_b16 v[222:223], v19 offset:18432
    v_exp_f32 v153, v153
    v_add_f32 v30, v30, v152
    v_xor_b32 v11, 0x10000, v11
    s_add_u32 m0, s8, 61440
    s_add_u32 s5, s5, 4096
    buffer_load_dwordx4 v21, s[28:31], s5 offen nt lds
    v_mfma_f32_32x32x16_bf16 v[160:175], v[192:195], v[128:131], v[160:175]
    ds_read_b64_tr_b16 v[224:225], v16 offset:20480
    ds_read_b64_tr_b16 v[226:227], v16 offset:22528
    v_exp_f32 v154, v154
    v_add_f32 v30, v30, v153
    v_cvt_pk_bf16_f32 v244, v152, v153
    v_mfma_f32_32x32x16_bf16 v[160:175], v[196:199], v[132:135], v[160:175]
    ds_read_b64_tr_b16 v[228:229], v17 offset:20480
    ds_read_b64_tr_b16 v[230:231], v17 offset:22528
    v_exp_f32 v155, v155
    v_add_f32 v30, v30, v154
    v_xor_b32 v13, 0x10000, v13
    v_mfma_f32_32x32x16_bf16 v[160:175], v[200:203], v[136:139], v[160:175]
    ds_read_b64_tr_b16 v[232:233], v18 offset:20480
    ds_read_b64_tr_b16 v[234:235], v18 offset:22528
    v_exp_f32 v156, v156
    v_add_f32 v30, v30, v155
    v_cvt_pk_bf16_f32 v245, v154, v155
    v_mfma_f32_32x32x16_bf16 v[160:175], v[204:207], v[140:143], v[160:175]
    s_waitcnt lgkmcnt(6)
    ds_read_b64_tr_b16 v[236:237], v19 offset:20480
    ds_read_b64_tr_b16 v[238:239], v19 offset:22528
    v_exp_f32 v157, v157
    v_add_f32 v30, v30, v156
    v_xor_b32 v15, 0x10000, v15
    v_mfma_f32_32x32x16_bf16 v[32:47], v[208:211], v[240:243], v[32:47]
    ds_read_b128 v[176:179], v8 offset:0
    ds_read_b128 v[180:183], v9 offset:0
    v_exp_f32 v158, v158
    v_add_f32 v30, v30, v157
    v_cvt_pk_bf16_f32 v246, v156, v157
    v_mfma_f32_32x32x16_bf16 v[48:63], v[212:215], v[240:243], v[48:63]
    ds_read_b128 v[184:187], v10 offset:0
    ds_read_b128 v[188:191], v11 offset:0
    v_exp_f32 v159, v159
    v_add_f32 v30, v30, v158
    v_mfma_f32_32x32x16_bf16 v[64:79], v[216:219], v[240:243], v[64:79]
    ds_read_b128 v[192:195], v12 offset:0
    ds_read_b128 v[196:199], v13 offset:0
    v_exp_f32 v160, v160
    v_add_f32 v30, v30, v159
    v_cvt_pk_bf16_f32 v247, v158, v159
    v_mfma_f32_32x32x16_bf16 v[80:95], v[220:223], v[240:243], v[80:95]
    s_waitcnt lgkmcnt(6)
    ds_read_b128 v[200:203], v14 offset:0
    ds_read_b128 v[204:207], v15 offset:0
    v_exp_f32 v161, v161
    v_add_f32 v30, v30, v160
    v_mfma_f32_32x32x16_bf16 v[32:47], v[224:227], v[244:247], v[32:47]
    v_exp_f32 v162, v162
    v_add_f32 v30, v30, v161
    v_cvt_pk_bf16_f32 v240, v160, v161
    v_mfma_f32_32x32x16_bf16 v[48:63], v[228:231], v[244:247], v[48:63]
    v_exp_f32 v163, v163
    v_add_f32 v30, v30, v162
    v_mfma_f32_32x32x16_bf16 v[64:79], v[232:235], v[244:247], v[64:79]
    v_exp_f32 v164, v164
    v_add_f32 v30, v30, v163
    v_cvt_pk_bf16_f32 v241, v162, v163
    v_mfma_f32_32x32x16_bf16 v[80:95], v[236:239], v[244:247], v[80:95]
    s_waitcnt lgkmcnt(0)
    v_exp_f32 v165, v165
    v_add_f32 v30, v30, v164
    v_mfma_f32_32x32x16_bf16 v[144:159], v[176:179], v[112:115], v[96:111]
    ds_read_b64_tr_b16 v[208:209], v16 offset:24576
    ds_read_b64_tr_b16 v[210:211], v16 offset:26624
    v_exp_f32 v166, v166
    v_add_f32 v30, v30, v165
    v_cvt_pk_bf16_f32 v242, v164, v165
    s_add_u32 s4, s24, 98304
    s_add_u32 m0, s8, 65536
    s_and_b32 s4, s4, 0x3ffff
    buffer_load_dwordx4 v20, s[68:71], s4 offen nt lds
    v_mfma_f32_32x32x16_bf16 v[144:159], v[180:183], v[116:119], v[144:159]
    ds_read_b64_tr_b16 v[212:213], v17 offset:24576
    ds_read_b64_tr_b16 v[214:215], v17 offset:26624
    v_exp_f32 v167, v167
    v_add_f32 v30, v30, v166
    s_add_u32 m0, s8, 69632
    s_add_u32 s4, s4, 4096
    buffer_load_dwordx4 v20, s[68:71], s4 offen nt lds
    v_mfma_f32_32x32x16_bf16 v[144:159], v[184:187], v[120:123], v[144:159]
    ds_read_b64_tr_b16 v[216:217], v18 offset:24576
    ds_read_b64_tr_b16 v[218:219], v18 offset:26624
    v_exp_f32 v168, v168
    v_add_f32 v30, v30, v167
    v_cvt_pk_bf16_f32 v243, v166, v167
    s_add_u32 m0, s8, 73728
    s_add_u32 s4, s4, 4096
    buffer_load_dwordx4 v20, s[68:71], s4 offen nt lds
    v_mfma_f32_32x32x16_bf16 v[144:159], v[188:191], v[124:127], v[144:159]
    ds_read_b64_tr_b16 v[220:221], v19 offset:24576
    ds_read_b64_tr_b16 v[222:223], v19 offset:26624
    v_exp_f32 v169, v169
    v_add_f32 v30, v30, v168
    s_add_u32 m0, s8, 77824
    s_add_u32 s4, s4, 4096
    buffer_load_dwordx4 v20, s[68:71], s4 offen nt lds
    v_mfma_f32_32x32x16_bf16 v[144:159], v[192:195], v[128:131], v[144:159]
    ds_read_b64_tr_b16 v[224:225], v16 offset:28672
    ds_read_b64_tr_b16 v[226:227], v16 offset:30720
    v_exp_f32 v170, v170
    v_add_f32 v30, v30, v169
    v_cvt_pk_bf16_f32 v244, v168, v169
    v_mfma_f32_32x32x16_bf16 v[144:159], v[196:199], v[132:135], v[144:159]
    ds_read_b64_tr_b16 v[228:229], v17 offset:28672
    ds_read_b64_tr_b16 v[230:231], v17 offset:30720
    v_exp_f32 v171, v171
    v_add_f32 v30, v30, v170
    v_mfma_f32_32x32x16_bf16 v[144:159], v[200:203], v[136:139], v[144:159]
    ds_read_b64_tr_b16 v[232:233], v18 offset:28672
    ds_read_b64_tr_b16 v[234:235], v18 offset:30720
    v_exp_f32 v172, v172
    v_add_f32 v30, v30, v171
    v_cvt_pk_bf16_f32 v245, v170, v171
    v_mfma_f32_32x32x16_bf16 v[144:159], v[204:207], v[140:143], v[144:159]
    s_waitcnt lgkmcnt(6)
    ds_read_b64_tr_b16 v[236:237], v19 offset:28672
    ds_read_b64_tr_b16 v[238:239], v19 offset:30720
    v_exp_f32 v173, v173
    v_add_f32 v30, v30, v172
    v_mfma_f32_32x32x16_bf16 v[32:47], v[208:211], v[240:243], v[32:47]
    ds_read_b128 v[176:179], v8 offset:8192
    ds_read_b128 v[180:183], v9 offset:8192
    v_exp_f32 v174, v174
    v_add_f32 v30, v30, v173
    v_cvt_pk_bf16_f32 v246, v172, v173
    v_mfma_f32_32x32x16_bf16 v[48:63], v[212:215], v[240:243], v[48:63]
    ds_read_b128 v[184:187], v10 offset:8192
    ds_read_b128 v[188:191], v11 offset:8192
    v_exp_f32 v175, v175
    v_add_f32 v30, v30, v174
    v_mfma_f32_32x32x16_bf16 v[64:79], v[216:219], v[240:243], v[64:79]
    ds_read_b128 v[192:195], v12 offset:8192
    ds_read_b128 v[196:199], v13 offset:8192
    v_exp_f32 v144, v144
    v_add_f32 v30, v30, v175
    v_cvt_pk_bf16_f32 v247, v174, v175
    v_mfma_f32_32x32x16_bf16 v[80:95], v[220:223], v[240:243], v[80:95]
    s_waitcnt lgkmcnt(6)
    ds_read_b128 v[200:203], v14 offset:8192
    ds_read_b128 v[204:207], v15 offset:8192
    v_exp_f32 v145, v145
    v_add_f32 v30, v30, v144
    v_mfma_f32_32x32x16_bf16 v[32:47], v[224:227], v[244:247], v[32:47]
    v_exp_f32 v146, v146
    v_add_f32 v30, v30, v145
    v_cvt_pk_bf16_f32 v240, v144, v145
    v_xor_b32 v16, 0x10000, v16
    v_mfma_f32_32x32x16_bf16 v[48:63], v[228:231], v[244:247], v[48:63]
    v_exp_f32 v147, v147
    v_add_f32 v30, v30, v146
    v_xor_b32 v17, 0x10000, v17
    v_mfma_f32_32x32x16_bf16 v[64:79], v[232:235], v[244:247], v[64:79]
    v_exp_f32 v148, v148
    v_add_f32 v30, v30, v147
    v_cvt_pk_bf16_f32 v241, v146, v147
    v_xor_b32 v18, 0x10000, v18
    v_mfma_f32_32x32x16_bf16 v[80:95], v[236:239], v[244:247], v[80:95]
    s_waitcnt lgkmcnt(0)
    v_exp_f32 v149, v149
    v_add_f32 v30, v30, v148
    v_xor_b32 v19, 0x10000, v19
    v_mfma_f32_32x32x16_bf16 v[160:175], v[176:179], v[112:115], v[96:111]
    s_waitcnt vmcnt(8)
    s_barrier
    ds_read_b64_tr_b16 v[208:209], v16 offset:0
    ds_read_b64_tr_b16 v[210:211], v16 offset:2048
    v_exp_f32 v150, v150
    v_add_f32 v30, v30, v149
    v_cvt_pk_bf16_f32 v242, v148, v149
    buffer_load_dwordx2 v[2:3], v6, s[64:67], s17 offen sc1
    v_mfma_f32_32x32x16_bf16 v[160:175], v[180:183], v[116:119], v[160:175]
    ds_read_b64_tr_b16 v[212:213], v17 offset:0
    ds_read_b64_tr_b16 v[214:215], v17 offset:2048
    v_exp_f32 v151, v151
    v_add_f32 v30, v30, v150
    s_add_u32 s5, s24, 98304
    s_add_u32 m0, s8, 98304
    s_and_b32 s5, s5, 0x3ffff
    buffer_load_dwordx4 v21, s[28:31], s5 offen nt lds
    v_mfma_f32_32x32x16_bf16 v[160:175], v[184:187], v[120:123], v[160:175]
    ds_read_b64_tr_b16 v[216:217], v18 offset:0
    ds_read_b64_tr_b16 v[218:219], v18 offset:2048
    v_exp_f32 v152, v152
    v_add_f32 v30, v30, v151
    v_cvt_pk_bf16_f32 v243, v150, v151
    s_add_u32 m0, s8, 102400
    s_add_u32 s5, s5, 4096
    buffer_load_dwordx4 v21, s[28:31], s5 offen nt lds
    v_mfma_f32_32x32x16_bf16 v[160:175], v[188:191], v[124:127], v[160:175]
    ds_read_b64_tr_b16 v[220:221], v19 offset:0
    ds_read_b64_tr_b16 v[222:223], v19 offset:2048
    v_exp_f32 v153, v153
    v_add_f32 v30, v30, v152
    s_add_u32 m0, s8, 106496
    s_add_u32 s5, s5, 4096
    buffer_load_dwordx4 v21, s[28:31], s5 offen nt lds
    v_mfma_f32_32x32x16_bf16 v[160:175], v[192:195], v[128:131], v[160:175]
    ds_read_b64_tr_b16 v[224:225], v16 offset:4096
    ds_read_b64_tr_b16 v[226:227], v16 offset:6144
    v_exp_f32 v154, v154
    v_add_f32 v30, v30, v153
    v_cvt_pk_bf16_f32 v244, v152, v153
    s_add_u32 m0, s8, 110592
    s_add_u32 s5, s5, 4096
    buffer_load_dwordx4 v21, s[28:31], s5 offen nt lds
    v_mfma_f32_32x32x16_bf16 v[160:175], v[196:199], v[132:135], v[160:175]
    ds_read_b64_tr_b16 v[228:229], v17 offset:4096
    ds_read_b64_tr_b16 v[230:231], v17 offset:6144
    v_exp_f32 v155, v155
    v_add_f32 v30, v30, v154
    s_add_u32 s4, s24, 114688
    s_add_u32 m0, s8, 81920
    s_and_b32 s4, s4, 0x3ffff
    buffer_load_dwordx4 v20, s[68:71], s4 offen nt lds
    v_mfma_f32_32x32x16_bf16 v[160:175], v[200:203], v[136:139], v[160:175]
    ds_read_b64_tr_b16 v[232:233], v18 offset:4096
    ds_read_b64_tr_b16 v[234:235], v18 offset:6144
    v_exp_f32 v156, v156
    v_add_f32 v30, v30, v155
    v_cvt_pk_bf16_f32 v245, v154, v155
    s_add_u32 m0, s8, 86016
    s_add_u32 s4, s4, 4096
    buffer_load_dwordx4 v20, s[68:71], s4 offen nt lds
    v_mfma_f32_32x32x16_bf16 v[160:175], v[204:207], v[140:143], v[160:175]
    s_waitcnt lgkmcnt(6)
    ds_read_b64_tr_b16 v[236:237], v19 offset:4096
    ds_read_b64_tr_b16 v[238:239], v19 offset:6144
    v_exp_f32 v157, v157
    v_add_f32 v30, v30, v156
    s_add_u32 m0, s8, 90112
    s_add_u32 s4, s4, 4096
    buffer_load_dwordx4 v20, s[68:71], s4 offen nt lds
    v_mfma_f32_32x32x16_bf16 v[32:47], v[208:211], v[240:243], v[32:47]
    ds_read_b128 v[176:179], v8 offset:16384
    ds_read_b128 v[180:183], v9 offset:16384
    v_exp_f32 v158, v158
    v_add_f32 v30, v30, v157
    v_cvt_pk_bf16_f32 v246, v156, v157
    s_add_u32 m0, s8, 94208
    s_add_u32 s4, s4, 4096
    buffer_load_dwordx4 v20, s[68:71], s4 offen nt lds
    v_mfma_f32_32x32x16_bf16 v[48:63], v[212:215], v[240:243], v[48:63]
    ds_read_b128 v[184:187], v10 offset:16384
    ds_read_b128 v[188:191], v11 offset:16384
    v_exp_f32 v159, v159
    v_add_f32 v30, v30, v158
    v_mfma_f32_32x32x16_bf16 v[64:79], v[216:219], v[240:243], v[64:79]
    ds_read_b128 v[192:195], v12 offset:16384
    ds_read_b128 v[196:199], v13 offset:16384
    v_exp_f32 v160, v160
    v_add_f32 v30, v30, v159
    v_cvt_pk_bf16_f32 v247, v158, v159
    v_mfma_f32_32x32x16_bf16 v[80:95], v[220:223], v[240:243], v[80:95]
    s_waitcnt lgkmcnt(6)
    ds_read_b128 v[200:203], v14 offset:16384
    ds_read_b128 v[204:207], v15 offset:16384
    v_exp_f32 v161, v161
    v_add_f32 v30, v30, v160
    v_mfma_f32_32x32x16_bf16 v[32:47], v[224:227], v[244:247], v[32:47]
    v_exp_f32 v162, v162
    v_add_f32 v30, v30, v161
    v_cvt_pk_bf16_f32 v240, v160, v161
    v_mfma_f32_32x32x16_bf16 v[48:63], v[228:231], v[244:247], v[48:63]
    v_exp_f32 v163, v163
    v_add_f32 v30, v30, v162
    v_mfma_f32_32x32x16_bf16 v[64:79], v[232:235], v[244:247], v[64:79]
    v_exp_f32 v164, v164
    v_add_f32 v30, v30, v163
    v_cvt_pk_bf16_f32 v241, v162, v163
    v_mfma_f32_32x32x16_bf16 v[80:95], v[236:239], v[244:247], v[80:95]
    s_waitcnt lgkmcnt(0)
    v_exp_f32 v165, v165
    v_add_f32 v30, v30, v164
    v_mfma_f32_32x32x16_bf16 v[144:159], v[176:179], v[112:115], v[96:111]
    ds_read_b64_tr_b16 v[208:209], v16 offset:8192
    ds_read_b64_tr_b16 v[210:211], v16 offset:10240
    v_exp_f32 v166, v166
    v_add_f32 v30, v30, v165
    v_cvt_pk_bf16_f32 v242, v164, v165
    s_add_u32 s5, s24, 114688
    s_add_u32 m0, s8, 114688
    s_and_b32 s5, s5, 0x3ffff
    buffer_load_dwordx4 v21, s[28:31], s5 offen nt lds
    v_mfma_f32_32x32x16_bf16 v[144:159], v[180:183], v[116:119], v[144:159]
    ds_read_b64_tr_b16 v[212:213], v17 offset:8192
    ds_read_b64_tr_b16 v[214:215], v17 offset:10240
    v_exp_f32 v167, v167
    v_add_f32 v30, v30, v166
    s_add_u32 m0, s8, 118784
    s_add_u32 s5, s5, 4096
    buffer_load_dwordx4 v21, s[28:31], s5 offen nt lds
    v_mfma_f32_32x32x16_bf16 v[144:159], v[184:187], v[120:123], v[144:159]
    ds_read_b64_tr_b16 v[216:217], v18 offset:8192
    ds_read_b64_tr_b16 v[218:219], v18 offset:10240
    v_exp_f32 v168, v168
    v_add_f32 v30, v30, v167
    v_cvt_pk_bf16_f32 v243, v166, v167
    s_add_u32 m0, s8, 122880
    s_add_u32 s5, s5, 4096
    buffer_load_dwordx4 v21, s[28:31], s5 offen nt lds
    v_mfma_f32_32x32x16_bf16 v[144:159], v[188:191], v[124:127], v[144:159]
    ds_read_b64_tr_b16 v[220:221], v19 offset:8192
    ds_read_b64_tr_b16 v[222:223], v19 offset:10240
    v_exp_f32 v169, v169
    v_add_f32 v30, v30, v168
    s_add_u32 m0, s8, 126976
    s_add_u32 s5, s5, 4096
    buffer_load_dwordx4 v21, s[28:31], s5 offen nt lds
    v_mfma_f32_32x32x16_bf16 v[144:159], v[192:195], v[128:131], v[144:159]
    ds_read_b64_tr_b16 v[224:225], v16 offset:12288
    ds_read_b64_tr_b16 v[226:227], v16 offset:14336
    v_exp_f32 v170, v170
    v_add_f32 v30, v30, v169
    v_cvt_pk_bf16_f32 v244, v168, v169
    s_add_u32 s4, s24, 131072
    s_add_u32 m0, s8, 0
    s_and_b32 s4, s4, 0x3ffff
    buffer_load_dwordx4 v20, s[68:71], s4 offen nt lds
    v_mfma_f32_32x32x16_bf16 v[144:159], v[196:199], v[132:135], v[144:159]
    ds_read_b64_tr_b16 v[228:229], v17 offset:12288
    ds_read_b64_tr_b16 v[230:231], v17 offset:14336
    v_exp_f32 v171, v171
    v_add_f32 v30, v30, v170
    s_add_u32 m0, s8, 4096
    s_add_u32 s4, s4, 4096
    buffer_load_dwordx4 v20, s[68:71], s4 offen nt lds
    v_mfma_f32_32x32x16_bf16 v[144:159], v[200:203], v[136:139], v[144:159]
    ds_read_b64_tr_b16 v[232:233], v18 offset:12288
    ds_read_b64_tr_b16 v[234:235], v18 offset:14336
    v_exp_f32 v172, v172
    v_add_f32 v30, v30, v171
    v_cvt_pk_bf16_f32 v245, v170, v171
    s_add_u32 m0, s8, 8192
    s_add_u32 s4, s4, 4096
    buffer_load_dwordx4 v20, s[68:71], s4 offen nt lds
    v_mfma_f32_32x32x16_bf16 v[144:159], v[204:207], v[140:143], v[144:159]
    s_waitcnt lgkmcnt(6)
    ds_read_b64_tr_b16 v[236:237], v19 offset:12288
    ds_read_b64_tr_b16 v[238:239], v19 offset:14336
    v_exp_f32 v173, v173
    v_add_f32 v30, v30, v172
    s_add_u32 m0, s8, 12288
    s_add_u32 s4, s4, 4096
    buffer_load_dwordx4 v20, s[68:71], s4 offen nt lds
    v_mfma_f32_32x32x16_bf16 v[32:47], v[208:211], v[240:243], v[32:47]
    ds_read_b128 v[176:179], v8 offset:24576
    ds_read_b128 v[180:183], v9 offset:24576
    v_exp_f32 v174, v174
    v_add_f32 v30, v30, v173
    v_cvt_pk_bf16_f32 v246, v172, v173
    v_mfma_f32_32x32x16_bf16 v[48:63], v[212:215], v[240:243], v[48:63]
    ds_read_b128 v[184:187], v10 offset:24576
    ds_read_b128 v[188:191], v11 offset:24576
    v_exp_f32 v175, v175
    v_add_f32 v30, v30, v174
    v_mfma_f32_32x32x16_bf16 v[64:79], v[216:219], v[240:243], v[64:79]
    ds_read_b128 v[192:195], v12 offset:24576
    ds_read_b128 v[196:199], v13 offset:24576
    v_exp_f32 v144, v144
    v_add_f32 v30, v30, v175
    v_cvt_pk_bf16_f32 v247, v174, v175
    v_mfma_f32_32x32x16_bf16 v[80:95], v[220:223], v[240:243], v[80:95]
    s_waitcnt lgkmcnt(6)
    ds_read_b128 v[200:203], v14 offset:24576
    ds_read_b128 v[204:207], v15 offset:24576
    v_exp_f32 v145, v145
    v_add_f32 v30, v30, v144
    v_mfma_f32_32x32x16_bf16 v[32:47], v[224:227], v[244:247], v[32:47]
    v_exp_f32 v146, v146
    v_add_f32 v30, v30, v145
    v_cvt_pk_bf16_f32 v240, v144, v145
    v_xor_b32 v8, 0x10000, v8
    v_mfma_f32_32x32x16_bf16 v[48:63], v[228:231], v[244:247], v[48:63]
    v_exp_f32 v147, v147
    v_add_f32 v30, v30, v146
    v_xor_b32 v10, 0x10000, v10
    v_mfma_f32_32x32x16_bf16 v[64:79], v[232:235], v[244:247], v[64:79]
    v_exp_f32 v148, v148
    v_add_f32 v30, v30, v147
    v_cvt_pk_bf16_f32 v241, v146, v147
    v_xor_b32 v12, 0x10000, v12
    v_mfma_f32_32x32x16_bf16 v[80:95], v[236:239], v[244:247], v[80:95]
    s_waitcnt lgkmcnt(0)
    v_exp_f32 v149, v149
    v_add_f32 v30, v30, v148
    v_xor_b32 v14, 0x10000, v14
    v_mfma_f32_32x32x16_bf16 v[160:175], v[176:179], v[112:115], v[96:111]
    s_waitcnt vmcnt(17)
    s_barrier
    ds_read_b64_tr_b16 v[208:209], v16 offset:16384
    ds_read_b64_tr_b16 v[210:211], v16 offset:18432
    v_exp_f32 v150, v150
    v_add_f32 v30, v30, v149
    v_cvt_pk_bf16_f32 v242, v148, v149
    s_add_u32 s5, s24, 131072
    s_add_u32 m0, s8, 32768
    s_and_b32 s5, s5, 0x3ffff
    buffer_load_dwordx4 v21, s[28:31], s5 offen nt lds
    v_mfma_f32_32x32x16_bf16 v[160:175], v[180:183], v[116:119], v[160:175]
    ds_read_b64_tr_b16 v[212:213], v17 offset:16384
    ds_read_b64_tr_b16 v[214:215], v17 offset:18432
    v_exp_f32 v151, v151
    v_add_f32 v30, v30, v150
    v_xor_b32 v9, 0x10000, v9
    s_add_u32 m0, s8, 36864
    s_add_u32 s5, s5, 4096
    buffer_load_dwordx4 v21, s[28:31], s5 offen nt lds
    v_mfma_f32_32x32x16_bf16 v[160:175], v[184:187], v[120:123], v[160:175]
    ds_read_b64_tr_b16 v[216:217], v18 offset:16384
    ds_read_b64_tr_b16 v[218:219], v18 offset:18432
    v_exp_f32 v152, v152
    v_add_f32 v30, v30, v151
    v_cvt_pk_bf16_f32 v243, v150, v151
    s_add_u32 m0, s8, 40960
    s_add_u32 s5, s5, 4096
    buffer_load_dwordx4 v21, s[28:31], s5 offen nt lds
    v_mfma_f32_32x32x16_bf16 v[160:175], v[188:191], v[124:127], v[160:175]
    ds_read_b64_tr_b16 v[220:221], v19 offset:16384
    ds_read_b64_tr_b16 v[222:223], v19 offset:18432
    v_exp_f32 v153, v153
    v_add_f32 v30, v30, v152
    v_xor_b32 v11, 0x10000, v11
    s_add_u32 m0, s8, 45056
    s_add_u32 s5, s5, 4096
    buffer_load_dwordx4 v21, s[28:31], s5 offen nt lds
    v_mfma_f32_32x32x16_bf16 v[160:175], v[192:195], v[128:131], v[160:175]
    ds_read_b64_tr_b16 v[224:225], v16 offset:20480
    ds_read_b64_tr_b16 v[226:227], v16 offset:22528
    v_exp_f32 v154, v154
    v_add_f32 v30, v30, v153
    v_cvt_pk_bf16_f32 v244, v152, v153
    v_mfma_f32_32x32x16_bf16 v[160:175], v[196:199], v[132:135], v[160:175]
    ds_read_b64_tr_b16 v[228:229], v17 offset:20480
    ds_read_b64_tr_b16 v[230:231], v17 offset:22528
    v_exp_f32 v155, v155
    v_add_f32 v30, v30, v154
    v_xor_b32 v13, 0x10000, v13
    v_mfma_f32_32x32x16_bf16 v[160:175], v[200:203], v[136:139], v[160:175]
    ds_read_b64_tr_b16 v[232:233], v18 offset:20480
    ds_read_b64_tr_b16 v[234:235], v18 offset:22528
    v_exp_f32 v156, v156
    v_add_f32 v30, v30, v155
    v_cvt_pk_bf16_f32 v245, v154, v155
    v_mfma_f32_32x32x16_bf16 v[160:175], v[204:207], v[140:143], v[160:175]
    s_waitcnt lgkmcnt(6)
    ds_read_b64_tr_b16 v[236:237], v19 offset:20480
    ds_read_b64_tr_b16 v[238:239], v19 offset:22528
    v_exp_f32 v157, v157
    v_add_f32 v30, v30, v156
    v_xor_b32 v15, 0x10000, v15
    v_mfma_f32_32x32x16_bf16 v[32:47], v[208:211], v[240:243], v[32:47]
    ds_read_b128 v[176:179], v8 offset:0
    ds_read_b128 v[180:183], v9 offset:0
    v_exp_f32 v158, v158
    v_add_f32 v30, v30, v157
    v_cvt_pk_bf16_f32 v246, v156, v157
    v_mfma_f32_32x32x16_bf16 v[48:63], v[212:215], v[240:243], v[48:63]
    ds_read_b128 v[184:187], v10 offset:0
    ds_read_b128 v[188:191], v11 offset:0
    v_exp_f32 v159, v159
    v_add_f32 v30, v30, v158
    v_mfma_f32_32x32x16_bf16 v[64:79], v[216:219], v[240:243], v[64:79]
    ds_read_b128 v[192:195], v12 offset:0
    ds_read_b128 v[196:199], v13 offset:0
    v_exp_f32 v160, v160
    v_add_f32 v30, v30, v159
    v_cvt_pk_bf16_f32 v247, v158, v159
    v_mfma_f32_32x32x16_bf16 v[80:95], v[220:223], v[240:243], v[80:95]
    s_waitcnt lgkmcnt(6)
    ds_read_b128 v[200:203], v14 offset:0
    ds_read_b128 v[204:207], v15 offset:0
    v_exp_f32 v161, v161
    v_add_f32 v30, v30, v160
    v_mfma_f32_32x32x16_bf16 v[32:47], v[224:227], v[244:247], v[32:47]
    v_exp_f32 v162, v162
    v_add_f32 v30, v30, v161
    v_cvt_pk_bf16_f32 v240, v160, v161
    v_mfma_f32_32x32x16_bf16 v[48:63], v[228:231], v[244:247], v[48:63]
    v_exp_f32 v163, v163
    v_add_f32 v30, v30, v162
    v_mfma_f32_32x32x16_bf16 v[64:79], v[232:235], v[244:247], v[64:79]
    v_exp_f32 v164, v164
    v_add_f32 v30, v30, v163
    v_cvt_pk_bf16_f32 v241, v162, v163
    v_mfma_f32_32x32x16_bf16 v[80:95], v[236:239], v[244:247], v[80:95]
    s_waitcnt lgkmcnt(0)
    v_exp_f32 v165, v165
    v_add_f32 v30, v30, v164
h_tail:
    s_add_u32 s4, s24, 147456
    s_add_u32 m0, s8, 16384
    s_and_b32 s4, s4, 0x3ffff
    buffer_load_dwordx4 v20, s[68:71], s4 offen nt lds
    s_add_u32 m0, s8, 20480
    s_add_u32 s4, s4, 4096
    buffer_load_dwordx4 v20, s[68:71], s4 offen nt lds
    s_add_u32 m0, s8, 24576
    s_add_u32 s4, s4, 4096
    buffer_load_dwordx4 v20, s[68:71], s4 offen nt lds
    s_add_u32 m0, s8, 28672
    s_add_u32 s4, s4, 4096
    buffer_load_dwordx4 v20, s[68:71], s4 offen nt lds
    ds_read_b64_tr_b16 v[208:209], v16 offset:24576
    ds_read_b64_tr_b16 v[210:211], v16 offset:26624
    ds_read_b64_tr_b16 v[212:213], v17 offset:24576
    ds_read_b64_tr_b16 v[214:215], v17 offset:26624
    ds_read_b64_tr_b16 v[216:217], v18 offset:24576
    ds_read_b64_tr_b16 v[218:219], v18 offset:26624
    ds_read_b64_tr_b16 v[220:221], v19 offset:24576
    ds_read_b64_tr_b16 v[222:223], v19 offset:26624
    v_exp_f32 v166, v166
    v_exp_f32 v167, v167
    v_add_f32 v30, v30, v165
    v_cvt_pk_bf16_f32 v242, v164, v165
    v_add_f32 v30, v30, v166
    v_add_f32 v30, v30, v167
    v_cvt_pk_bf16_f32 v243, v166, v167
    ds_read_b64_tr_b16 v[224:225], v16 offset:28672
    ds_read_b64_tr_b16 v[226:227], v16 offset:30720
    ds_read_b64_tr_b16 v[228:229], v17 offset:28672
    ds_read_b64_tr_b16 v[230:231], v17 offset:30720
    ds_read_b64_tr_b16 v[232:233], v18 offset:28672
    ds_read_b64_tr_b16 v[234:235], v18 offset:30720
    ds_read_b64_tr_b16 v[236:237], v19 offset:28672
    ds_read_b64_tr_b16 v[238:239], v19 offset:30720
    s_waitcnt lgkmcnt(14)
    v_mfma_f32_32x32x16_bf16 v[32:47], v[208:211], v[240:243], v[32:47]
    v_exp_f32 v168, v168
    v_exp_f32 v169, v169
    s_nop 0
    v_add_f32 v30, v30, v168
    s_waitcnt lgkmcnt(12)
    v_mfma_f32_32x32x16_bf16 v[48:63], v[212:215], v[240:243], v[48:63]
    v_exp_f32 v170, v170
    v_exp_f32 v171, v171
    v_add_f32 v30, v30, v169
    v_cvt_pk_bf16_f32 v244, v168, v169
    v_add_f32 v30, v30, v170
    s_waitcnt lgkmcnt(10)
    v_mfma_f32_32x32x16_bf16 v[64:79], v[216:219], v[240:243], v[64:79]
    v_exp_f32 v172, v172
    v_exp_f32 v173, v173
    v_add_f32 v30, v30, v171
    v_cvt_pk_bf16_f32 v245, v170, v171
    v_add_f32 v30, v30, v172
    s_waitcnt lgkmcnt(8)
    v_mfma_f32_32x32x16_bf16 v[80:95], v[220:223], v[240:243], v[80:95]
    v_exp_f32 v174, v174
    v_exp_f32 v175, v175
    v_add_f32 v30, v30, v173
    v_cvt_pk_bf16_f32 v246, v172, v173
    v_add_f32 v30, v30, v174
    v_add_f32 v30, v30, v175
    v_cvt_pk_bf16_f32 v247, v174, v175
    s_waitcnt lgkmcnt(0)
    s_waitcnt vmcnt(16)
    s_barrier
    v_mfma_f32_32x32x16_bf16 v[32:47], v[224:227], v[244:247], v[32:47]
    v_mfma_f32_32x32x16_bf16 v[48:63], v[228:231], v[244:247], v[48:63]
    v_mfma_f32_32x32x16_bf16 v[64:79], v[232:235], v[244:247], v[64:79]
    v_mfma_f32_32x32x16_bf16 v[80:95], v[236:239], v[244:247], v[80:95]
    v_lshlrev_b32 v1, 2, v0
    v_cmp_ne_u64 vcc, s[14:15], v[2:3]
    s_cbranch_vccz h_dok
    s_mov_b32 s12, 0
h_polld:
    buffer_load_dwordx2 v[2:3], v6, s[64:67], s17 offen sc1
    s_add_u32 s12, s12, 1
    s_cmp_gt_u32 s12, 262144
    s_cbranch_scc1 h_polld_x
    s_waitcnt vmcnt(0)
    v_cmp_ne_u64 vcc, s[14:15], v[2:3]
    s_cmp_lg_u64 vcc, 0
    s_cbranch_scc1 h_polld
h_polld_x:
h_dok:
    s_nop 5
    v_cvt_pk_bf16_f32 v176, v32, v33
    v_cvt_pk_bf16_f32 v177, v34, v35
    v_cvt_pk_bf16_f32 v178, v36, v37
    v_cvt_pk_bf16_f32 v179, v38, v39
    buffer_store_dwordx4 v[176:179], v27, s[60:63], s20 offen offset:0
    v_cvt_pk_bf16_f32 v180, v40, v41
    v_cvt_pk_bf16_f32 v181, v42, v43
    v_cvt_pk_bf16_f32 v182, v44, v45
    v_cvt_pk_bf16_f32 v183, v46, v47
    buffer_store_dwordx4 v[180:183], v27, s[60:63], s20 offen offset:1024
    v_cvt_pk_bf16_f32 v184, v48, v49
    v_cvt_pk_bf16_f32 v185, v50, v51
    v_cvt_pk_bf16_f32 v186, v52, v53
    v_cvt_pk_bf16_f32 v187, v54, v55
    buffer_store_dwordx4 v[184:187], v27, s[60:63], s20 offen offset:2048
    v_cvt_pk_bf16_f32 v188, v56, v57
    v_cvt_pk_bf16_f32 v189, v58, v59
    v_cvt_pk_bf16_f32 v190, v60, v61
    v_cvt_pk_bf16_f32 v191, v62, v63
    buffer_store_dwordx4 v[188:191], v27, s[60:63], s20 offen offset:3072
    v_cvt_pk_bf16_f32 v192, v64, v65
    v_cvt_pk_bf16_f32 v193, v66, v67
    v_cvt_pk_bf16_f32 v194, v68, v69
    v_cvt_pk_bf16_f32 v195, v70, v71
    buffer_store_dwordx4 v[192:195], v27, s[60:63], s21 offen offset:0
    v_cvt_pk_bf16_f32 v196, v72, v73
    v_cvt_pk_bf16_f32 v197, v74, v75
    v_cvt_pk_bf16_f32 v198, v76, v77
    v_cvt_pk_bf16_f32 v199, v78, v79
    buffer_store_dwordx4 v[196:199], v27, s[60:63], s21 offen offset:1024
    v_cvt_pk_bf16_f32 v200, v80, v81
    v_cvt_pk_bf16_f32 v201, v82, v83
    v_cvt_pk_bf16_f32 v202, v84, v85
    v_cvt_pk_bf16_f32 v203, v86, v87
    buffer_store_dwordx4 v[200:203], v27, s[60:63], s21 offen offset:2048
    v_cvt_pk_bf16_f32 v204, v88, v89
    v_cvt_pk_bf16_f32 v205, v90, v91
    v_cvt_pk_bf16_f32 v206, v92, v93
    v_cvt_pk_bf16_f32 v207, v94, v95
    buffer_store_dwordx4 v[204:207], v27, s[60:63], s21 offen offset:3072
    buffer_store_dword v30, v1, s[60:63], s22 offen
    s_add_u32 s5, s24, 147456
    s_add_u32 m0, s8, 49152
    s_and_b32 s5, s5, 0x3ffff
    buffer_load_dwordx4 v21, s[28:31], s5 offen nt lds
    s_add_u32 m0, s8, 53248
    s_add_u32 s5, s5, 4096
    buffer_load_dwordx4 v21, s[28:31], s5 offen nt lds
    s_add_u32 m0, s8, 57344
    s_add_u32 s5, s5, 4096
    buffer_load_dwordx4 v21, s[28:31], s5 offen nt lds
    s_add_u32 m0, s8, 61440
    s_add_u32 s5, s5, 4096
    buffer_load_dwordx4 v21, s[28:31], s5 offen nt lds
    s_add_u32 s16, s16, 4096
    s_add_u32 s17, s17, 4096
    s_xor_b32 s20, s20, 0x20000
    s_xor_b32 s21, s21, 0x20000
    s_waitcnt vmcnt(21)
    s_barrier
    s_cmp_eq_u32 s26, 0
    s_mov_b64 exec, 1
    s_waitcnt vmcnt(4)
    s_cbranch_scc1 fx_s
    buffer_store_dwordx2 v[4:5], v6, s[64:67], s16 offen
fx_d:
    s_mov_b64 exec, -1
    s_add_u32 s54, s13, 0
    s_and_b32 s54, s54, 15
    s_add_u32 m0, s8, 98304
    s_lshl_b32 s54, s54, 17
    buffer_load_dwordx4 v22, s[56:59], s54 offen  lds
    s_add_u32 m0, s8, 102400
    s_add_u32 s54, s54, 32768
    buffer_load_dwordx4 v22, s[56:59], s54 offen  lds
    s_add_u32 m0, s8, 106496
    s_add_u32 s54, s54, 32768
    buffer_load_dwordx4 v22, s[56:59], s54 offen  lds
    s_add_u32 m0, s8, 110592
    s_add_u32 s54, s54, 32768
    buffer_load_dwordx4 v22, s[56:59], s54 offen  lds
    s_barrier
    buffer_load_dwordx2 v[2:3], v6, s[64:67], s17 offen sc1
    s_waitcnt vmcnt(0)
    v_cmp_ne_u64 vcc, s[14:15], v[2:3]
    s_cbranch_vccnz h_late
    s_cmp_eq_u32 s26, 0
    s_cbranch_scc1 h_acq1_s
h_acq1_d:
    s_lshl_b32 s49, s7, 13
    s_lshl_b32 s50, s7, 12
    s_add_u32 m0, s49, 65536
    s_nop 0
    buffer_load_dwordx4 v27, s[60:63], s20 offen offset:0 sc1 lds
    buffer_load_dwordx4 v27, s[60:63], s20 offen offset:1024 sc1 lds
    buffer_load_dwordx4 v27, s[60:63], s20 offen offset:2048 sc1 lds
    buffer_load_dwordx4 v27, s[60:63], s20 offen offset:3072 sc1 lds
    s_add_u32 m0, s49, 69632
    s_nop 0
    buffer_load_dwordx4 v27, s[60:63], s21 offen offset:0 sc1 lds
    buffer_load_dwordx4 v27, s[60:63], s21 offen offset:1024 sc1 lds
    buffer_load_dwordx4 v27, s[60:63], s21 offen offset:2048 sc1 lds
    buffer_load_dwordx4 v27, s[60:63], s21 offen offset:3072 sc1 lds
    s_add_u32 m0, s50, 133120
    s_nop 0
    buffer_load_dword v1, s[60:63], s23 offen sc1 lds
    s_add_u32 s54, s13, 1
    s_and_b32 s54, s54, 15
    s_add_u32 m0, s8, 114688
    s_lshl_b32 s54, s54, 17
    buffer_load_dwordx4 v22, s[56:59], s54 offen  lds
    s_add_u32 m0, s8, 118784
    s_add_u32 s54, s54, 32768
    buffer_load_dwordx4 v22, s[56:59], s54 offen  lds
    s_add_u32 m0, s8, 122880
    s_add_u32 s54, s54, 32768
    buffer_load_dwordx4 v22, s[56:59], s54 offen  lds
    s_add_u32 m0, s8, 126976
    s_add_u32 s54, s54, 32768
    buffer_load_dwordx4 v22, s[56:59], s54 offen  lds
    s_barrier
    s_add_u32 s54, s13, 2
    s_and_b32 s54, s54, 15
    s_add_u32 m0, s8, 32768
    s_lshl_b32 s54, s54, 17
    buffer_load_dwordx4 v22, s[56:59], s54 offen  lds
    s_add_u32 m0, s8, 36864
    s_add_u32 s54, s54, 32768
    buffer_load_dwordx4 v22, s[56:59], s54 offen  lds
    s_add_u32 m0, s8, 40960
    s_add_u32 s54, s54, 32768
    buffer_load_dwordx4 v22, s[56:59], s54 offen  lds
    s_add_u32 m0, s8, 45056
    s_add_u32 s54, s54, 32768
    buffer_load_dwordx4 v22, s[56:59], s54 offen  lds
    s_waitcnt vmcnt(8)
lb_end:
    s_setprio 0
    v_mov_b32 v6, 134144
    s_mov_b32 s4, s13
    s_mov_b32 s53, 0
    s_barrier
    s_barrier
    ds_read_b128 v[16:19], v6
    s_waitcnt lgkmcnt(0)
    v_or3_b32 v16, v16, v17, v18
    v_or_b32 v16, v16, v19
    s_nop 0
    v_readfirstlane_b32 s51, v16
    s_cmp_lg_u32 s51, 0
    s_cbranch_scc1 lb_redo
    s_add_u32 s3, s8, 65536
    s_mov_b32 s78, 0x953c8421
    s_mov_b32 s79, 0xfb7ea6d
    v_lshl_add_u32 v55, v0, 1, 1
    v_mul_lo_u32 v55, v55, s14
    v_lshlrev_b32 v58, 2, v0
    s_and_b32 s49, s48, 3
    s_lshl_b32 s49, s49, 4
    v_and_b32 v57, 0xcc, v58
    v_or_b32 v57, s49, v57
    s_and_b32 s49, s2, 0xfc
    s_lshl_b32 s49, s49, 15
    s_lshl_b32 s50, s43, 9
    s_add_u32 s49, s49, s50
    s_lshr_b32 s50, s48, 2
    s_lshl_b32 s50, s50, 8
    s_add_u32 s49, s49, s50
    s_add_u32 s49, s49, 16777216
    s_add_u32 s50, s43, 1
    s_and_b32 s50, s50, 3
    s_mul_i32 s50, s50, 40960
    s_add_u32 s91, s50, s49
    s_add_u32 s50, s43, 2
    s_and_b32 s50, s50, 3
    s_mul_i32 s50, s50, 40960
    s_add_u32 s92, s50, s49
    s_add_u32 s50, s43, 3
    s_and_b32 s50, s50, 3
    s_mul_i32 s50, s50, 40960
    s_add_u32 s93, s50, s49
    s_add_u32 s82, s13, 0
    s_and_b32 s82, s82, 15
    s_lshl_b32 s83, s82, 17
    s_lshl_b32 s82, s82, 14
    s_add_u32 m0, s8, 65536
    s_mov_b32 s12, 0
c_pollo:
    buffer_load_dwordx2 v[2:3], v24, s[64:67], s10 offen sc1
    s_add_u32 s12, s12, 1
    s_cmp_gt_u32 s12, 262144
    s_cbranch_scc1 c_pollo_x
    s_waitcnt vmcnt(0)
    v_cmp_ne_u64 vcc, s[14:15], v[2:3]
    s_cmp_lg_u64 vcc, 0
    s_cbranch_scc1 c_pollo
c_pollo_x:
    s_cmp_eq_u32 s26, 0
    s_cbranch_scc1 c_acq_s
c_acq_d:
    buffer_load_dwordx4 v23, s[60:63], s82 offen sc1 lds
    s_add_u32 m0, s8, 69632
    s_add_u32 s82, s82, 4096
    s_add_u32 s84, s13, 1
    s_and_b32 s84, s84, 15
    buffer_load_dwordx4 v23, s[60:63], s82 offen sc1 lds
    s_add_u32 m0, s8, 73728
    s_add_u32 s82, s82, 4096
    s_lshl_b32 s85, s84, 17
    s_lshl_b32 s84, s84, 14
    buffer_load_dwordx4 v23, s[60:63], s82 offen sc1 lds
    s_add_u32 m0, s8, 77824
    s_add_u32 s82, s82, 4096
    buffer_load_dwordx4 v23, s[60:63], s82 offen sc1 lds
    s_add_u32 m0, s8, 81920
    s_nop 0
    buffer_load_dwordx4 v23, s[60:63], s84 offen sc1 lds
    s_add_u32 m0, s8, 86016
    s_add_u32 s84, s84, 4096
    s_add_u32 s82, s13, 2
    s_and_b32 s82, s82, 15
    buffer_load_dwordx4 v23, s[60:63], s84 offen sc1 lds
    s_add_u32 m0, s8, 90112
    s_add_u32 s84, s84, 4096
    s_lshl_b32 s83, s82, 17
    s_lshl_b32 s82, s82, 14
    buffer_load_dwordx4 v23, s[60:63], s84 offen sc1 lds
    s_add_u32 m0, s8, 94208
    s_add_u32 s84, s84, 4096
    buffer_load_dwordx4 v23, s[60:63], s84 offen sc1 lds
    s_add_u32 m0, s8, 0
    s_waitcnt vmcnt(4)
    s_barrier
    buffer_load_dwordx4 v23, s[60:63], s82 offen sc1 lds
    s_add_u32 m0, s8, 4096
    s_add_u32 s82, s82, 4096
    s_add_u32 s84, s13, 4
    s_and_b32 s84, s84, 15
    buffer_load_dwordx4 v23, s[60:63], s82 offen sc1 lds
    s_add_u32 m0, s8, 8192
    s_add_u32 s82, s82, 4096
    s_lshl_b32 s85, s84, 17
    s_lshl_b32 s84, s84, 14
    buffer_load_dwordx4 v23, s[60:63], s82 offen sc1 lds
    s_add_u32 m0, s8, 12288
    s_add_u32 s82, s82, 4096
    buffer_load_dwordx4 v23, s[60:63], s82 offen sc1 lds
    s_add_u32 m0, s8, 49152
    s_nop 0
    buffer_load_dwordx4 v22, s[56:59], s85 offen  lds
    s_add_u32 m0, s8, 16384
    s_add_u32 s82, s13, 8
    buffer_load_dwordx4 v23, s[60:63], s84 offen sc1 lds
    s_add_u32 m0, s8, 53248
    s_add_u32 s85, s85, 32768
    s_and_b32 s82, s82, 15
    buffer_load_dwordx4 v22, s[56:59], s85 offen  lds
    s_add_u32 m0, s8, 20480
    s_add_u32 s84, s84, 4096
    s_lshl_b32 s83, s82, 17
    buffer_load_dwordx4 v23, s[60:63], s84 offen sc1 lds
    s_add_u32 m0, s8, 57344
    s_add_u32 s85, s85, 32768
    s_lshl_b32 s82, s82, 14
    buffer_load_dwordx4 v22, s[56:59], s85 offen  lds
    s_add_u32 m0, s8, 24576
    s_add_u32 s84, s84, 4096
    buffer_load_dwordx4 v23, s[60:63], s84 offen sc1 lds
    s_add_u32 m0, s8, 61440
    s_add_u32 s85, s85, 32768
    buffer_load_dwordx4 v22, s[56:59], s85 offen  lds
    s_add_u32 m0, s8, 28672
    s_add_u32 s84, s84, 4096
    buffer_load_dwordx4 v23, s[60:63], s84 offen sc1 lds
    s_add_u32 m0, s8, 98304
    s_waitcnt vmcnt(12)
    s_barrier
    buffer_load_dwordx4 v22, s[56:59], s83 offen  lds
    s_add_u32 m0, s8, 65536
    s_add_u32 s84, s13, 12
    buffer_load_dwordx4 v23, s[60:63], s82 offen sc1 lds
    s_add_u32 m0, s8, 102400
    s_add_u32 s83, s83, 32768
    s_and_b32 s84, s84, 15
    buffer_load_dwordx4 v22, s[56:59], s83 offen  lds
    s_add_u32 m0, s8, 69632
    s_add_u32 s82, s82, 4096
    s_lshl_b32 s85, s84, 17
    buffer_load_dwordx4 v23, s[60:63], s82 offen sc1 lds
    s_add_u32 m0, s8, 106496
    s_add_u32 s83, s83, 32768
    s_lshl_b32 s84, s84, 14
    buffer_load_dwordx4 v22, s[56:59], s83 offen  lds
    s_add_u32 m0, s8, 73728
    s_add_u32 s82, s82, 4096
    buffer_load_dwordx4 v23, s[60:63], s82 offen sc1 lds
    s_add_u32 m0, s8, 110592
    s_add_u32 s83, s83, 32768
    buffer_load_dwordx4 v22, s[56:59], s83 offen  lds
    s_add_u32 m0, s8, 77824
    s_add_u32 s82, s82, 4096
    buffer_load_dwordx4 v23, s[60:63], s82 offen sc1 lds
    s_add_u32 m0, s8, 114688
    s_waitcnt vmcnt(16)
    s_barrier
    buffer_load_dwordx4 v22, s[56:59], s85 offen  lds
    s_add_u32 m0, s8, 81920
    s_add_u32 s82, s13, 3
    buffer_load_dwordx4 v23, s[60:63], s84 offen sc1 lds
    s_add_u32 m0, s8, 118784
    s_add_u32 s85, s85, 32768
    s_and_b32 s82, s82, 15
    buffer_load_dwordx4 v22, s[56:59], s85 offen  lds
    s_add_u32 m0, s8, 86016
    s_add_u32 s84, s84, 4096
    s_lshl_b32 s83, s82, 17
    buffer_load_dwordx4 v23, s[60:63], s84 offen sc1 lds
    s_add_u32 m0, s8, 122880
    s_add_u32 s85, s85, 32768
    s_lshl_b32 s82, s82, 14
    buffer_load_dwordx4 v22, s[56:59], s85 offen  lds
    s_add_u32 m0, s8, 90112
    s_add_u32 s84, s84, 4096
    buffer_load_dwordx4 v23, s[60:63], s84 offen sc1 lds
    s_add_u32 m0, s8, 126976
    s_add_u32 s85, s85, 32768
    buffer_load_dwordx4 v22, s[56:59], s85 offen  lds
    s_add_u32 m0, s8, 94208
    s_add_u32 s84, s84, 4096
    buffer_load_dwordx4 v23, s[60:63], s84 offen sc1 lds
    s_add_u32 m0, s8, 32768
    s_waitcnt vmcnt(16)
    s_barrier
    buffer_load_dwordx4 v22, s[56:59], s83 offen  lds
    s_add_u32 m0, s8, 0
    s_add_u32 s84, s13, 5
    buffer_load_dwordx4 v23, s[60:63], s82 offen sc1 lds
    s_add_u32 m0, s8, 36864
    s_add_u32 s83, s83, 32768
    s_and_b32 s84, s84, 15
    buffer_load_dwordx4 v22, s[56:59], s83 offen  lds
    s_add_u32 m0, s8, 4096
    s_add_u32 s82, s82, 4096
    s_lshl_b32 s85, s84, 17
    buffer_load_dwordx4 v23, s[60:63], s82 offen sc1 lds
    s_add_u32 m0, s8, 40960
    s_add_u32 s83, s83, 32768
    s_lshl_b32 s84, s84, 14
    buffer_load_dwordx4 v22, s[56:59], s83 offen  lds
    s_add_u32 m0, s8, 8192
    s_add_u32 s82, s82, 4096
    buffer_load_dwordx4 v23, s[60:63], s82 offen sc1 lds
    s_add_u32 m0, s8, 45056
    s_add_u32 s83, s83, 32768
    buffer_load_dwordx4 v22, s[56:59], s83 offen  lds
    s_add_u32 m0, s8, 12288
    s_add_u32 s82, s82, 4096
    buffer_load_dwordx4 v23, s[60:63], s82 offen sc1 lds
    s_add_u32 m0, s8, 49152
    s_waitcnt vmcnt(16)
    s_barrier
    buffer_load_dwordx4 v22, s[56:59], s85 offen  lds
    s_add_u32 m0, s8, 16384
    s_add_u32 s82, s13, 9
    buffer_load_dwordx4 v23, s[60:63], s84 offen sc1 lds
    s_add_u32 m0, s8, 53248
    s_add_u32 s85, s85, 32768
    s_and_b32 s82, s82, 15
    buffer_load_dwordx4 v22, s[56:59], s85 offen  lds
    s_add_u32 m0, s8, 20480
    s_add_u32 s84, s84, 4096
    s_lshl_b32 s83, s82, 17
    buffer_load_dwordx4 v23, s[60:63], s84 offen sc1 lds
    s_add_u32 m0, s8, 57344
    s_add_u32 s85, s85, 32768
    s_lshl_b32 s82, s82, 14
    buffer_load_dwordx4 v22, s[56:59], s85 offen  lds
    s_add_u32 m0, s8, 24576
    s_add_u32 s84, s84, 4096
    buffer_load_dwordx4 v23, s[60:63], s84 offen sc1 lds
    s_add_u32 m0, s8, 61440
    s_add_u32 s85, s85, 32768
    buffer_load_dwordx4 v22, s[56:59], s85 offen  lds
    s_add_u32 m0, s8, 28672
    s_add_u32 s84, s84, 4096
    buffer_load_dwordx4 v23, s[60:63], s84 offen sc1 lds
    s_add_u32 m0, s8, 98304
    s_waitcnt vmcnt(16)
    s_barrier
    buffer_load_dwordx4 v22, s[56:59], s83 offen  lds
    s_add_u32 m0, s8, 65536
    s_add_u32 s84, s13, 13
    buffer_load_dwordx4 v23, s[60:63], s82 offen sc1 lds
    s_add_u32 m0, s8, 102400
    s_add_u32 s83, s83, 32768
    s_and_b32 s84, s84, 15
    buffer_load_dwordx4 v22, s[56:59], s83 offen  lds
    s_add_u32 m0, s8, 69632
    s_add_u32 s82, s82, 4096
    s_lshl_b32 s85, s84, 17
    buffer_load_dwordx4 v23, s[60:63], s82 offen sc1 lds
    s_add_u32 m0, s8, 106496
    s_add_u32 s83, s83, 32768
    s_lshl_b32 s84, s84, 14
    buffer_load_dwordx4 v22, s[56:59], s83 offen  lds
    s_add_u32 m0, s8, 73728
    s_add_u32 s82, s82, 4096
    buffer_load_dwordx4 v23, s[60:63], s82 offen sc1 lds
    s_add_u32 m0, s8, 110592
    s_add_u32 s83, s83, 32768
    buffer_load_dwordx4 v22, s[56:59], s83 offen  lds
    s_add_u32 m0, s8, 77824
    s_add_u32 s82, s82, 4096
    buffer_load_dwordx4 v23, s[60:63], s82 offen sc1 lds
    s_add_u32 m0, s8, 114688
    s_waitcnt vmcnt(16)
    s_barrier
    buffer_load_dwordx4 v22, s[56:59], s85 offen  lds
    s_add_u32 m0, s8, 81920
    s_add_u32 s82, s13, 6
    buffer_load_dwordx4 v23, s[60:63], s84 offen sc1 lds
    s_add_u32 m0, s8, 118784
    s_add_u32 s85, s85, 32768
    s_and_b32 s82, s82, 15
    buffer_load_dwordx4 v22, s[56:59], s85 offen  lds
    s_add_u32 m0, s8, 86016
    s_add_u32 s84, s84, 4096
    s_lshl_b32 s83, s82, 17
    buffer_load_dwordx4 v23, s[60:63], s84 offen sc1 lds
    s_add_u32 m0, s8, 122880
    s_add_u32 s85, s85, 32768
    s_lshl_b32 s82, s82, 14
    buffer_load_dwordx4 v22, s[56:59], s85 offen  lds
    s_add_u32 m0, s8, 90112
    s_add_u32 s84, s84, 4096
    buffer_load_dwordx4 v23, s[60:63], s84 offen sc1 lds
    s_add_u32 m0, s8, 126976
    s_add_u32 s85, s85, 32768
    buffer_load_dwordx4 v22, s[56:59], s85 offen  lds
    s_add_u32 m0, s8, 94208
    s_add_u32 s84, s84, 4096
    buffer_load_dwordx4 v23, s[60:63], s84 offen sc1 lds
    s_add_u32 m0, s8, 32768
    s_waitcnt vmcnt(16)
    s_barrier
    buffer_load_dwordx4 v22, s[56:59], s83 offen  lds
    s_add_u32 m0, s8, 0
    s_add_u32 s84, s13, 10
    buffer_load_dwordx4 v23, s[60:63], s82 offen sc1 lds
    s_add_u32 m0, s8, 36864
    s_add_u32 s83, s83, 32768
    s_and_b32 s84, s84, 15
    buffer_load_dwordx4 v22, s[56:59], s83 offen  lds
    s_add_u32 m0, s8, 4096
    s_add_u32 s82, s82, 4096
    s_lshl_b32 s85, s84, 17
    buffer_load_dwordx4 v23, s[60:63], s82 offen sc1 lds
    s_add_u32 m0, s8, 40960
    s_add_u32 s83, s83, 32768
    s_lshl_b32 s84, s84, 14
    buffer_load_dwordx4 v22, s[56:59], s83 offen  lds
    s_add_u32 m0, s8, 8192
    s_add_u32 s82, s82, 4096
    buffer_load_dwordx4 v23, s[60:63], s82 offen sc1 lds
    s_add_u32 m0, s8, 45056
    s_add_u32 s83, s83, 32768
    buffer_load_dwordx4 v22, s[56:59], s83 offen  lds
    s_add_u32 m0, s8, 12288
    s_add_u32 s82, s82, 4096
    buffer_load_dwordx4 v23, s[60:63], s82 offen sc1 lds
    s_add_u32 m0, s8, 49152
    s_waitcnt vmcnt(16)
    s_barrier
    buffer_load_dwordx4 v22, s[56:59], s85 offen  lds
    s_add_u32 m0, s8, 16384
    s_add_u32 s82, s13, 14
    buffer_load_dwordx4 v23, s[60:63], s84 offen sc1 lds
    s_add_u32 m0, s8, 53248
    s_add_u32 s85, s85, 32768
    s_and_b32 s82, s82, 15
    buffer_load_dwordx4 v22, s[56:59], s85 offen  lds
    s_add_u32 m0, s8, 20480
    s_add_u32 s84, s84, 4096
    s_lshl_b32 s83, s82, 17
    buffer_load_dwordx4 v23, s[60:63], s84 offen sc1 lds
    s_add_u32 m0, s8, 57344
    s_add_u32 s85, s85, 32768
    s_lshl_b32 s82, s82, 14
    buffer_load_dwordx4 v22, s[56:59], s85 offen  lds
    s_add_u32 m0, s8, 24576
    s_add_u32 s84, s84, 4096
    buffer_load_dwordx4 v23, s[60:63], s84 offen sc1 lds
    s_add_u32 m0, s8, 61440
    s_add_u32 s85, s85, 32768
    buffer_load_dwordx4 v22, s[56:59], s85 offen  lds
    s_add_u32 m0, s8, 28672
    s_add_u32 s84, s84, 4096
    buffer_load_dwordx4 v23, s[60:63], s84 offen sc1 lds
    s_add_u32 m0, s8, 98304
    s_waitcnt vmcnt(16)
    s_barrier
    buffer_load_dwordx4 v22, s[56:59], s83 offen  lds
    s_add_u32 m0, s8, 65536
    s_add_u32 s84, s13, 7
    buffer_load_dwordx4 v23, s[60:63], s82 offen sc1 lds
    s_add_u32 m0, s8, 102400
    s_add_u32 s83, s83, 32768
    s_and_b32 s84, s84, 15
    buffer_load_dwordx4 v22, s[56:59], s83 offen  lds
    s_add_u32 m0, s8, 69632
    s_add_u32 s82, s82, 4096
    s_lshl_b32 s85, s84, 17
    buffer_load_dwordx4 v23, s[60:63], s82 offen sc1 lds
    s_add_u32 m0, s8, 106496
    s_add_u32 s83, s83, 32768
    s_lshl_b32 s84, s84, 14
    buffer_load_dwordx4 v22, s[56:59], s83 offen  lds
    s_add_u32 m0, s8, 73728
    s_add_u32 s82, s82, 4096
    buffer_load_dwordx4 v23, s[60:63], s82 offen sc1 lds
    s_add_u32 m0, s8, 110592
    s_add_u32 s83, s83, 32768
    buffer_load_dwordx4 v22, s[56:59], s83 offen  lds
    s_add_u32 m0, s8, 77824
    s_add_u32 s82, s82, 4096
    buffer_load_dwordx4 v23, s[60:63], s82 offen sc1 lds
    s_add_u32 m0, s8, 114688
    s_waitcnt vmcnt(16)
    s_barrier
    buffer_load_dwordx4 v22, s[56:59], s85 offen  lds
    s_add_u32 m0, s8, 81920
    s_add_u32 s82, s13, 11
    buffer_load_dwordx4 v23, s[60:63], s84 offen sc1 lds
    s_add_u32 m0, s8, 118784
    s_add_u32 s85, s85, 32768
    s_and_b32 s82, s82, 15
    buffer_load_dwordx4 v22, s[56:59], s85 offen  lds
    s_add_u32 m0, s8, 86016
    s_add_u32 s84, s84, 4096
    s_lshl_b32 s83, s82, 17
    buffer_load_dwordx4 v23, s[60:63], s84 offen sc1 lds
    s_add_u32 m0, s8, 122880
    s_add_u32 s85, s85, 32768
    s_lshl_b32 s82, s82, 14
    buffer_load_dwordx4 v22, s[56:59], s85 offen  lds
    s_add_u32 m0, s8, 90112
    s_add_u32 s84, s84, 4096
    buffer_load_dwordx4 v23, s[60:63], s84 offen sc1 lds
    s_add_u32 m0, s8, 126976
    s_add_u32 s85, s85, 32768
    buffer_load_dwordx4 v22, s[56:59], s85 offen  lds
    s_add_u32 m0, s8, 94208
    s_add_u32 s84, s84, 4096
    buffer_load_dwordx4 v23, s[60:63], s84 offen sc1 lds
    s_add_u32 m0, s8, 32768
    s_waitcnt vmcnt(16)
    s_barrier
    buffer_load_dwordx4 v22, s[56:59], s83 offen  lds
    s_add_u32 m0, s8, 0
    s_add_u32 s84, s13, 15
    buffer_load_dwordx4 v23, s[60:63], s82 offen sc1 lds
    s_add_u32 m0, s8, 36864
    s_add_u32 s83, s83, 32768
    s_and_b32 s84, s84, 15
    buffer_load_dwordx4 v22, s[56:59], s83 offen  lds
    s_add_u32 m0, s8, 4096
    s_add_u32 s82, s82, 4096
    s_lshl_b32 s85, s84, 17
    buffer_load_dwordx4 v23, s[60:63], s82 offen sc1 lds
    s_add_u32 m0, s8, 40960
    s_add_u32 s83, s83, 32768
    s_lshl_b32 s84, s84, 14
    buffer_load_dwordx4 v22, s[56:59], s83 offen  lds
    s_add_u32 m0, s8, 8192
    s_add_u32 s82, s82, 4096
    buffer_load_dwordx4 v23, s[60:63], s82 offen sc1 lds
    s_add_u32 m0, s8, 45056
    s_add_u32 s83, s83, 32768
    buffer_load_dwordx4 v22, s[56:59], s83 offen  lds
    s_add_u32 m0, s8, 12288
    s_add_u32 s82, s82, 4096
    buffer_load_dwordx4 v23, s[60:63], s82 offen sc1 lds
    s_add_u32 m0, s8, 49152
    s_waitcnt vmcnt(16)
    s_barrier
    buffer_load_dwordx4 v22, s[56:59], s85 offen  lds
    s_add_u32 m0, s8, 16384
    s_nop 0
    buffer_load_dwordx4 v23, s[60:63], s84 offen sc1 lds
    s_add_u32 m0, s8, 53248
    s_add_u32 s85, s85, 32768
    buffer_load_dwordx4 v22, s[56:59], s85 offen  lds
    s_add_u32 m0, s8, 20480
    s_add_u32 s84, s84, 4096
    buffer_load_dwordx4 v23, s[60:63], s84 offen sc1 lds
    s_add_u32 m0, s8, 57344
    s_add_u32 s85, s85, 32768
    buffer_load_dwordx4 v22, s[56:59], s85 offen  lds
    s_add_u32 m0, s8, 24576
    s_add_u32 s84, s84, 4096
    buffer_load_dwordx4 v23, s[60:63], s84 offen sc1 lds
    s_add_u32 m0, s8, 61440
    s_add_u32 s85, s85, 32768
    buffer_load_dwordx4 v22, s[56:59], s85 offen  lds
    s_add_u32 m0, s8, 28672
    s_add_u32 s84, s84, 4096
    buffer_load_dwordx4 v23, s[60:63], s84 offen sc1 lds
    s_waitcnt vmcnt(16)
    s_barrier
    s_waitcnt vmcnt(8)
    s_barrier
    s_waitcnt vmcnt(0)
    s_barrier
    s_barrier
    s_branch c_final
h_late:
    s_barrier
    s_mov_b32 s12, 0
h_pollx:
    buffer_load_dwordx2 v[2:3], v6, s[64:67], s17 offen sc1
    s_add_u32 s12, s12, 1
    s_cmp_gt_u32 s12, 262144
    s_cbranch_scc1 h_pollx_x
    s_waitcnt vmcnt(0)
    v_cmp_ne_u64 vcc, s[14:15], v[2:3]
    s_cmp_lg_u64 vcc, 0
    s_cbranch_scc1 h_pollx
h_pollx_x:
    s_cmp_eq_u32 s26, 0
    s_cbranch_scc1 h_acq2_s
h_acq2_d:
    s_lshl_b32 s49, s7, 13
    s_lshl_b32 s50, s7, 12
    s_add_u32 m0, s49, 65536
    s_nop 0
    buffer_load_dwordx4 v27, s[60:63], s20 offen offset:0 sc1 lds
    buffer_load_dwordx4 v27, s[60:63], s20 offen offset:1024 sc1 lds
    buffer_load_dwordx4 v27, s[60:63], s20 offen offset:2048 sc1 lds
    buffer_load_dwordx4 v27, s[60:63], s20 offen offset:3072 sc1 lds
    s_add_u32 m0, s49, 69632
    s_nop 0
    buffer_load_dwordx4 v27, s[60:63], s21 offen offset:0 sc1 lds
    buffer_load_dwordx4 v27, s[60:63], s21 offen offset:1024 sc1 lds
    buffer_load_dwordx4 v27, s[60:63], s21 offen offset:2048 sc1 lds
    buffer_load_dwordx4 v27, s[60:63], s21 offen offset:3072 sc1 lds
    s_add_u32 m0, s50, 133120
    s_nop 0
    buffer_load_dword v1, s[60:63], s23 offen sc1 lds
    s_add_u32 s54, s13, 1
    s_and_b32 s54, s54, 15
    s_add_u32 m0, s8, 114688
    s_lshl_b32 s54, s54, 17
    buffer_load_dwordx4 v22, s[56:59], s54 offen  lds
    s_add_u32 m0, s8, 118784
    s_add_u32 s54, s54, 32768
    buffer_load_dwordx4 v22, s[56:59], s54 offen  lds
    s_add_u32 m0, s8, 122880
    s_add_u32 s54, s54, 32768
    buffer_load_dwordx4 v22, s[56:59], s54 offen  lds
    s_add_u32 m0, s8, 126976
    s_add_u32 s54, s54, 32768
    buffer_load_dwordx4 v22, s[56:59], s54 offen  lds
    s_add_u32 s54, s13, 2
    s_and_b32 s54, s54, 15
    s_add_u32 m0, s8, 32768
    s_lshl_b32 s54, s54, 17
    buffer_load_dwordx4 v22, s[56:59], s54 offen  lds
    s_add_u32 m0, s8, 36864
    s_add_u32 s54, s54, 32768
    buffer_load_dwordx4 v22, s[56:59], s54 offen  lds
    s_add_u32 m0, s8, 40960
    s_add_u32 s54, s54, 32768
    buffer_load_dwordx4 v22, s[56:59], s54 offen  lds
    s_add_u32 m0, s8, 45056
    s_add_u32 s54, s54, 32768
    buffer_load_dwordx4 v22, s[56:59], s54 offen  lds
    s_waitcnt vmcnt(8)
    s_branch lb_end
lb_redo:
    s_waitcnt vmcnt(0)
    s_barrier
    s_add_u32 s51, s9, 0
    s_and_b32 s51, s51, 0x3ffff
    s_add_u32 m0, s8, 65536
    s_nop 0
    buffer_load_dwordx4 v20, s[68:71], s51 offen nt lds
    s_add_u32 m0, s8, 69632
    s_add_u32 s51, s51, 4096
    buffer_load_dwordx4 v20, s[68:71], s51 offen nt lds
    s_add_u32 m0, s8, 73728
    s_add_u32 s51, s51, 4096
    buffer_load_dwordx4 v20, s[68:71], s51 offen nt lds
    s_add_u32 m0, s8, 77824
    s_add_u32 s51, s51, 4096
    buffer_load_dwordx4 v20, s[68:71], s51 offen nt lds
    s_add_u32 s51, s9, 0
    s_and_b32 s51, s51, 0x3ffff
    s_add_u32 m0, s8, 98304
    s_nop 0
    buffer_load_dwordx4 v21, s[28:31], s51 offen nt lds
    s_add_u32 m0, s8, 102400
    s_add_u32 s51, s51, 4096
    buffer_load_dwordx4 v21, s[28:31], s51 offen nt lds
    s_add_u32 m0, s8, 106496
    s_add_u32 s51, s51, 4096
    buffer_load_dwordx4 v21, s[28:31], s51 offen nt lds
    s_add_u32 m0, s8, 110592
    s_add_u32 s51, s51, 4096
    buffer_load_dwordx4 v21, s[28:31], s51 offen nt lds
    s_add_u32 s51, s9, 16384
    s_and_b32 s51, s51, 0x3ffff
    s_add_u32 m0, s8, 81920
    s_nop 0
    buffer_load_dwordx4 v20, s[68:71], s51 offen nt lds
    s_add_u32 m0, s8, 86016
    s_add_u32 s51, s51, 4096
    buffer_load_dwordx4 v20, s[68:71], s51 offen nt lds
    s_add_u32 m0, s8, 90112
    s_add_u32 s51, s51, 4096
    buffer_load_dwordx4 v20, s[68:71], s51 offen nt lds
    s_add_u32 m0, s8, 94208
    s_add_u32 s51, s51, 4096
    buffer_load_dwordx4 v20, s[68:71], s51 offen nt lds
    s_add_u32 s51, s9, 16384
    s_and_b32 s51, s51, 0x3ffff
    s_add_u32 m0, s8, 114688
    s_nop 0
    buffer_load_dwordx4 v21, s[28:31], s51 offen nt lds
    s_add_u32 m0, s8, 118784
    s_add_u32 s51, s51, 4096
    buffer_load_dwordx4 v21, s[28:31], s51 offen nt lds
    s_add_u32 m0, s8, 122880
    s_add_u32 s51, s51, 4096
    buffer_load_dwordx4 v21, s[28:31], s51 offen nt lds
    s_add_u32 m0, s8, 126976
    s_add_u32 s51, s51, 4096
    buffer_load_dwordx4 v21, s[28:31], s51 offen nt lds
    s_add_u32 s51, s9, 32768
    s_and_b32 s51, s51, 0x3ffff
    s_add_u32 m0, s8, 0
    s_nop 0
    buffer_load_dwordx4 v20, s[68:71], s51 offen nt lds
    s_add_u32 m0, s8, 4096
    s_add_u32 s51, s51, 4096
    buffer_load_dwordx4 v20, s[68:71], s51 offen nt lds
    s_add_u32 m0, s8, 8192
    s_add_u32 s51, s51, 4096
    buffer_load_dwordx4 v20, s[68:71], s51 offen nt lds
    s_add_u32 m0, s8, 12288
    s_add_u32 s51, s51, 4096
    buffer_load_dwordx4 v20, s[68:71], s51 offen nt lds
    s_add_u32 s51, s9, 32768
    s_and_b32 s51, s51, 0x3ffff
    s_add_u32 m0, s8, 32768
    s_nop 0
    buffer_load_dwordx4 v21, s[28:31], s51 offen nt lds
    s_add_u32 m0, s8, 36864
    s_add_u32 s51, s51, 4096
    buffer_load_dwordx4 v21, s[28:31], s51 offen nt lds
    s_add_u32 m0, s8, 40960
    s_add_u32 s51, s51, 4096
    buffer_load_dwordx4 v21, s[28:31], s51 offen nt lds
    s_add_u32 m0, s8, 45056
    s_add_u32 s51, s51, 4096
    buffer_load_dwordx4 v21, s[28:31], s51 offen nt lds
    s_add_u32 s51, s9, 49152
    s_and_b32 s51, s51, 0x3ffff
    s_add_u32 m0, s8, 16384
    s_nop 0
    buffer_load_dwordx4 v20, s[68:71], s51 offen nt lds
    s_add_u32 m0, s8, 20480
    s_add_u32 s51, s51, 4096
    buffer_load_dwordx4 v20, s[68:71], s51 offen nt lds
    s_add_u32 m0, s8, 24576
    s_add_u32 s51, s51, 4096
    buffer_load_dwordx4 v20, s[68:71], s51 offen nt lds
    s_add_u32 m0, s8, 28672
    s_add_u32 s51, s51, 4096
    buffer_load_dwordx4 v20, s[68:71], s51 offen nt lds
    s_waitcnt vmcnt(24)
    s_barrier
    s_mov_b32 s53, 0
    s_mov_b32 s4, 65536
    s_mov_b32 s5, 49152
    s_add_u32 s50, s8, 16384
    s_add_u32 s52, s8, 65536
lb_loop:
    s_mov_b32 s49, s50
    s_mov_b32 s50, s52
    s_add_u32 s52, s52, 16384
    s_and_b32 s51, s52, 0x8000
    s_mul_i32 s51, s51, 3
    s_xor_b32 s52, s52, s51
    s_add_u32 s51, s5, s9
    s_and_b32 s51, s51, 0x3ffff
    s_add_u32 s54, s4, s9
    s_and_b32 s54, s54, 0x3ffff
    s_add_u32 s5, s5, 16384
    s_add_u32 s4, s4, 16384
    s_waitcnt vmcnt(16)
    s_barrier
    s_add_u32 m0, s49, 32768
    s_nop 0
    buffer_load_dwordx4 v21, s[28:31], s51 offen nt lds
    s_add_u32 m0, s49, 36864
    s_add_u32 s51, s51, 4096
    buffer_load_dwordx4 v21, s[28:31], s51 offen nt lds
    s_add_u32 m0, s49, 40960
    s_add_u32 s51, s51, 4096
    buffer_load_dwordx4 v21, s[28:31], s51 offen nt lds
    s_add_u32 m0, s49, 45056
    s_add_u32 s51, s51, 4096
    buffer_load_dwordx4 v21, s[28:31], s51 offen nt lds
    s_cmp_eq_u32 s53, 12
    s_cbranch_scc1 lb_tail
    s_add_u32 m0, s50, 0
    s_nop 0
    buffer_load_dwordx4 v20, s[68:71], s54 offen nt lds
    s_add_u32 m0, s50, 4096
    s_add_u32 s54, s54, 4096
    buffer_load_dwordx4 v20, s[68:71], s54 offen nt lds
    s_add_u32 m0, s50, 8192
    s_add_u32 s54, s54, 4096
    buffer_load_dwordx4 v20, s[68:71], s54 offen nt lds
    s_add_u32 m0, s50, 12288
    s_add_u32 s54, s54, 4096
    buffer_load_dwordx4 v20, s[68:71], s54 offen nt lds
    s_add_u32 s53, s53, 1
    s_branch lb_loop
lb_tail:
    s_waitcnt vmcnt(12)
    s_barrier
    s_add_u32 s54, s13, 0
    s_and_b32 s54, s54, 15
    s_lshl_b32 s54, s54, 17
    s_add_u32 m0, s8, 98304
    s_nop 0
    buffer_load_dwordx4 v22, s[56:59], s54 offen  lds
    s_add_u32 m0, s8, 102400
    s_add_u32 s54, s54, 32768
    buffer_load_dwordx4 v22, s[56:59], s54 offen  lds
    s_add_u32 m0, s8, 106496
    s_add_u32 s54, s54, 32768
    buffer_load_dwordx4 v22, s[56:59], s54 offen  lds
    s_add_u32 m0, s8, 110592
    s_add_u32 s54, s54, 32768
    buffer_load_dwordx4 v22, s[56:59], s54 offen  lds
    s_waitcnt vmcnt(8)
    s_barrier
    s_add_u32 s54, s13, 1
    s_and_b32 s54, s54, 15
    s_lshl_b32 s54, s54, 17
    s_add_u32 m0, s8, 114688
    s_nop 0
    buffer_load_dwordx4 v22, s[56:59], s54 offen  lds
    s_add_u32 m0, s8, 118784
    s_add_u32 s54, s54, 32768
    buffer_load_dwordx4 v22, s[56:59], s54 offen  lds
    s_add_u32 m0, s8, 122880
    s_add_u32 s54, s54, 32768
    buffer_load_dwordx4 v22, s[56:59], s54 offen  lds
    s_add_u32 m0, s8, 126976
    s_add_u32 s54, s54, 32768
    buffer_load_dwordx4 v22, s[56:59], s54 offen  lds
    s_waitcnt vmcnt(8)
    s_barrier
    s_add_u32 s54, s13, 2
    s_and_b32 s54, s54, 15
    s_lshl_b32 s54, s54, 17
    s_add_u32 m0, s8, 32768
    s_nop 0
    buffer_load_dwordx4 v22, s[56:59], s54 offen  lds
    s_add_u32 m0, s8, 36864
    s_add_u32 s54, s54, 32768
    buffer_load_dwordx4 v22, s[56:59], s54 offen  lds
    s_add_u32 m0, s8, 40960
    s_add_u32 s54, s54, 32768
    buffer_load_dwordx4 v22, s[56:59], s54 offen  lds
    s_add_u32 m0, s8, 45056
    s_add_u32 s54, s54, 32768
    buffer_load_dwordx4 v22, s[56:59], s54 offen  lds
    s_branch lb_end
g_compute:
    s_lshl_b32 s49, s48, 5
    s_add_u32 s49, s49, s44
    s_cmp_ge_u32 s49, 24
    s_cbranch_scc1 g_nononce
    s_memrealtime s[14:15]
    s_mov_b32 s56, s38
    s_mov_b32 s57, s39
    s_mov_b32 s58, 256
    s_getreg_b32 s49, hwreg(HW_REG_XCC_ID, 0, 4)
    s_and_b32 s49, s49, 7
    s_lshl_b32 s49, s49, 2
    s_lshl_b32 s49, 1, s49
    v_mov_b32 v7, s49
    s_and_b32 s49, s2, 7
    s_lshl_b32 s49, s49, 2
    s_add_u32 s49, s49, s47
    s_lshl_b32 s49, s49, 2
    s_add_u32 s49, s49, 128
    s_waitcnt lgkmcnt(0)
    s_or_b32 s14, s14, 1
    v_mov_b32 v4, s14
    v_mov_b32 v5, 0
    v_mov_b32 v6, 0
    s_mov_b64 exec, 1
    buffer_atomic_cmpswap v[4:5], v6, s[56:59], 0 offen
    s_mov_b64 exec, -1
    s_nop 0
g_nononce:
    s_mov_b32 s64, s40
    s_mov_b32 s65, s41
    s_mov_b32 s66, 268435456
    s_mov_b32 s67, 0x20000
    s_lshl_b32 s49, s45, 2
    s_add_u32 s49, s49, s43
    s_lshl_b32 s49, s49, 18
    s_add_u32 s68, s18, s49
    s_addc_u32 s69, s19, 0
    s_mov_b32 s70, 262144
    s_mov_b32 s71, 0x20000
    s_add_u32 s28, s20, s49
    s_addc_u32 s29, s21, 0
    s_mov_b32 s30, 262144
    s_mov_b32 s31, 0x20000
    s_and_b32 s27, s2, 7
    s_lshl_b32 s27, s27, 2
    s_add_u32 s27, s27, s47
    s_and_b32 s49, s2, 0xfc
    s_lshl_b32 s49, s49, 15
    s_lshl_b32 s50, s43, 3
    s_add_u32 s50, s50, s48
    s_lshl_b32 s50, s50, 10
    s_add_u32 s49, s49, s50
    s_add_u32 s0, s49, 16777216
    v_lshlrev_b32 v27, 4, v0
    s_lshl_b32 s50, s48, 11
    s_add_u32 s50, s50, 131072
    v_add_u32 v248, s50, v27
    s_mov_b32 s32, s36
    s_mov_b32 s33, s37
    s_mov_b32 s34, 2097152
    s_mov_b32 s35, 0x20000
    v_and_b32 v3, 15, v0
    v_lshlrev_b32 v3, 12, v3
    v_bfe_u32 v4, v0, 4, 1
    v_lshl_add_u32 v3, v4, 5, v3
    v_lshrrev_b32 v4, 5, v0
    v_lshl_add_u32 v249, v4, 4, v3
    s_lshl_b32 s49, s47, 2
    s_add_u32 s49, s49, s43
    s_lshl_b32 s49, s49, 1
    s_bfe_u32 s50, s48, 0x10001
    s_add_u32 s49, s49, s50
    s_lshl_b32 s49, s49, 16
    s_lshl_b32 s50, s42, 11
    s_add_u32 s49, s49, s50
    s_and_b32 s50, s44, 7
    s_lshl_b32 s50, s50, 8
    s_add_u32 s49, s49, s50
    s_lshr_b32 s50, s48, 2
    s_lshl_b32 s50, s50, 7
    s_add_u32 s49, s49, s50
    s_and_b32 s50, s48, 1
    s_lshl_b32 s50, s50, 6
    s_add_u32 s1, s49, s50
    s_mov_b32 s9, 0
    s_mov_b32 s8, 0
    s_mov_b32 s6, 0
    s_and_b32 s49, s48, 1
    s_lshr_b32 s50, s48, 1
    s_lshl_b32 s13, s50, 1
    s_lshl_b32 s52, s2, 15
    s_lshl_b32 s53, s50, 14
    s_add_u32 s52, s52, s53
    s_lshl_b32 s53, s49, 12
    s_add_u32 s52, s52, s53
    s_add_u32 s23, s52, 16777216
    s_lshl_b32 s53, s49, 13
    s_add_u32 s53, s53, 131072
    v_add_u32 v250, s53, v27
    v_and_b32 v1, 15, v0
    v_lshrrev_b32 v2, 4, v0
    v_lshrrev_b32 v3, 1, v1
    v_xor_b32 v3, v3, v2
    v_lshlrev_b32 v3, 4, v3
    v_lshl_add_u32 v3, v1, 7, v3
    s_lshl_b32 s52, s50, 13
    s_add_u32 s52, s52, 32768
    v_add_u32 v24, s52, v3
    v_xor_b32 v25, 64, v24
    v_lshrrev_b32 v3, 2, v1
    v_and_b32 v4, 3, v0
    v_lshl_add_u32 v5, v2, 3, v3
    v_and_b32 v6, 1, v2
    v_lshl_add_u32 v6, v6, 2, v3
    v_lshlrev_b32 v6, 5, v6
    v_lshl_add_u32 v6, v4, 3, v6
    v_lshl_add_u32 v6, v5, 8, v6
    s_lshl_b32 s52, s49, 7
    s_add_u32 s52, s52, 0x10000
    v_xor_b32 v20, s52, v6
    v_xor_b32 v21, 32, v20
    v_xor_b32 v22, 64, v20
    v_xor_b32 v23, 96, v20
    s_mov_b32 s24, 0x3e0293ee
    s_mov_b32 s25, s24
    v_and_b32 v3, 1, v2
    v_lshlrev_b32 v3, 10, v3
    v_lshrrev_b32 v4, 1, v2
    v_lshl_add_u32 v3, v4, 9, v3
    v_lshl_add_u32 v26, v1, 4, v3
    s_and_b32 s51, s55, 7
    s_lshl_b32 s51, s51, 1
    s_add_u32 s51, s51, s49
    s_lshl_b32 s51, s51, 2
    s_add_u32 s51, s51, s13
    s_lshl_b32 s16, s51, 12
    s_add_u32 s17, s16, 4096
    s_lshl_b32 s54, s27, 19
    s_add_u32 s19, s54, 262144
    s_and_b32 s51, s44, 7
    s_lshl_b32 s51, s51, 2
    s_add_u32 s51, s51, s48
    s_lshl_b32 s51, s51, 3
    s_add_u32 s18, s51, s19
    s_lshl_b32 s52, s2, 5
    s_lshl_b32 s53, s48, 3
    s_add_u32 s52, s52, s53
    s_add_u32 s4, s52, 25165824
    s_mov_b32 s5, 99
    s_mov_b32 s10, 4
    s_mov_b32 s11, 0x10000
    s_mov_b32 s3, 0x30000
    s_lshl_b32 s52, s48, 13
    s_add_u32 s52, s52, 65536
    v_add_u32 v251, s52, v27
    s_lshl_b32 s52, s48, 12
    s_add_u32 s52, s52, 131072
    v_add_u32 v252, s52, v27
    v_lshl_add_u32 v253, v0, 2, s52
    v_and_b32 v3, 31, v0
    v_lshlrev_b32 v28, 3, v3
    s_lshl_b32 s49, s27, 19
    s_add_u32 s60, s40, s49
    s_addc_u32 s61, s41, 0
    s_mov_b32 s62, 524288
    s_mov_b32 s63, 0x20000
    v_bfe_u32 v3, v0, 4, 1
    v_lshlrev_b32 v3, 11, v3
    v_lshrrev_b32 v4, 5, v0
    v_lshl_add_u32 v3, v4, 8, v3
    v_lshl_add_u32 v29, v1, 4, v3
    s_lshl_b32 s53, s46, 2
    s_add_u32 s53, s53, s7
    s_lshl_b32 s53, s53, 3
    s_and_b32 s52, s45, 3
    s_add_u32 s52, s52, s53
    s_lshl_b32 s20, s52, 12
    s_add_u32 s21, s20, 16384
    s_lshl_b32 s49, s27, 19
    s_and_b32 s50, s44, 7
    s_lshl_b32 s50, s50, 2
    s_add_u32 s50, s50, s48
    s_lshl_b32 s50, s50, 3
    s_add_u32 s49, s49, s50
    s_add_u32 s22, s49, 266240
    v_lshrrev_b32 v3, 1, v0
    v_lshlrev_b32 v3, 12, v3
    v_and_b32 v4, 1, v0
    v_lshl_add_u32 v3, v4, 7, v3
    s_lshl_b32 s50, s50, 5
    s_xor_b32 s50, s50, 1024
    v_cmp_lt_u32 vcc, 7, v0
    v_mov_b32 v4, s50
    s_mov_b32 s49, 262144
    v_cndmask_b32 v4, 0, v4, vcc
    v_add_u32 v3, v3, v4
    s_mov_b64 exec, 0x3ff
    buffer_load_dword v240, v3, s[60:63], s49 offen sc1
    s_mov_b64 exec, -1
    v_and_b32 v1, 31, v0
    v_lshrrev_b32 v2, 5, v0
    v_and_b32 v3, 15, v0
    v_xor_b32 v3, v3, v2
    v_lshlrev_b32 v3, 4, v3
    v_lshl_add_u32 v8, v1, 8, v3
    v_xor_b32 v9, 32, v8
    v_xor_b32 v10, 64, v8
    v_xor_b32 v11, 96, v8
    v_xor_b32 v12, 128, v8
    v_xor_b32 v13, 160, v8
    v_xor_b32 v14, 192, v8
    v_xor_b32 v15, 224, v8
    v_bfe_u32 v3, v0, 2, 2
    v_lshl_add_u32 v5, v2, 2, v3
    v_lshlrev_b32 v5, 8, v5
    v_lshl_add_u32 v5, v3, 6, v5
    v_bfe_u32 v6, v0, 4, 1
    v_lshl_add_u32 v5, v6, 5, v5
    v_and_b32 v6, 3, v0
    v_lshl_add_u32 v5, v6, 3, v5
    v_add_u32 v16, 0x8000, v5
    v_xor_b32 v17, 64, v16
    v_xor_b32 v18, 128, v16
    v_xor_b32 v19, 192, v16
    v_pk_mov_b32 v[32:33], 0, 0
    v_pk_mov_b32 v[34:35], 0, 0
    v_pk_mov_b32 v[36:37], 0, 0
    v_pk_mov_b32 v[38:39], 0, 0
    v_pk_mov_b32 v[40:41], 0, 0
    v_pk_mov_b32 v[42:43], 0, 0
    v_pk_mov_b32 v[44:45], 0, 0
    v_pk_mov_b32 v[46:47], 0, 0
    v_pk_mov_b32 v[48:49], 0, 0
    v_pk_mov_b32 v[50:51], 0, 0
    v_pk_mov_b32 v[52:53], 0, 0
    v_pk_mov_b32 v[54:55], 0, 0
    v_pk_mov_b32 v[56:57], 0, 0
    v_pk_mov_b32 v[58:59], 0, 0
    v_pk_mov_b32 v[60:61], 0, 0
    v_pk_mov_b32 v[62:63], 0, 0
    v_pk_mov_b32 v[64:65], 0, 0
    v_pk_mov_b32 v[66:67], 0, 0
    v_pk_mov_b32 v[68:69], 0, 0
    v_pk_mov_b32 v[70:71], 0, 0
    v_pk_mov_b32 v[72:73], 0, 0
    v_pk_mov_b32 v[74:75], 0, 0
    v_pk_mov_b32 v[76:77], 0, 0
    v_pk_mov_b32 v[78:79], 0, 0
    v_pk_mov_b32 v[80:81], 0, 0
    v_pk_mov_b32 v[82:83], 0, 0
    v_pk_mov_b32 v[84:85], 0, 0
    v_pk_mov_b32 v[86:87], 0, 0
    v_pk_mov_b32 v[88:89], 0, 0
    v_pk_mov_b32 v[90:91], 0, 0
    v_pk_mov_b32 v[92:93], 0, 0
    v_pk_mov_b32 v[94:95], 0, 0
    v_mov_b32 v30, 0
    v_pk_mov_b32 v[96:97], 0, 0
    v_pk_mov_b32 v[98:99], 0, 0
    v_pk_mov_b32 v[100:101], 0, 0
    v_pk_mov_b32 v[102:103], 0, 0
    v_pk_mov_b32 v[104:105], 0, 0
    v_pk_mov_b32 v[106:107], 0, 0
    v_pk_mov_b32 v[108:109], 0, 0
    v_pk_mov_b32 v[110:111], 0, 0
g_common:
    v_pk_mov_b32 v[112:113], 0, 0
    v_pk_mov_b32 v[114:115], 0, 0
    v_pk_mov_b32 v[116:117], 0, 0
    v_pk_mov_b32 v[118:119], 0, 0
    v_pk_mov_b32 v[120:121], 0, 0
    v_pk_mov_b32 v[122:123], 0, 0
    v_pk_mov_b32 v[124:125], 0, 0
    v_pk_mov_b32 v[126:127], 0, 0
    v_pk_mov_b32 v[128:129], 0, 0
    v_pk_mov_b32 v[130:131], 0, 0
    v_pk_mov_b32 v[132:133], 0, 0
    v_pk_mov_b32 v[134:135], 0, 0
    v_pk_mov_b32 v[136:137], 0, 0
    v_pk_mov_b32 v[138:139], 0, 0
    v_pk_mov_b32 v[140:141], 0, 0
    v_pk_mov_b32 v[142:143], 0, 0
    v_pk_mov_b32 v[144:145], 0, 0
    v_pk_mov_b32 v[146:147], 0, 0
    v_pk_mov_b32 v[148:149], 0, 0
    v_pk_mov_b32 v[150:151], 0, 0
    v_pk_mov_b32 v[152:153], 0, 0
    v_pk_mov_b32 v[154:155], 0, 0
    v_pk_mov_b32 v[156:157], 0, 0
    v_pk_mov_b32 v[158:159], 0, 0
    v_pk_mov_b32 v[160:161], 0, 0
    v_pk_mov_b32 v[162:163], 0, 0
    v_pk_mov_b32 v[164:165], 0, 0
    v_pk_mov_b32 v[166:167], 0, 0
    v_pk_mov_b32 v[168:169], 0, 0
    v_pk_mov_b32 v[170:171], 0, 0
    v_pk_mov_b32 v[172:173], 0, 0
    v_pk_mov_b32 v[174:175], 0, 0
    s_mov_b32 s53, 0
    v_mov_b32 v7, 134208
    s_barrier
    ds_read_b64_tr_b16 v[176:177], v20 offset:0
    ds_read_b64_tr_b16 v[178:179], v20 offset:1024
    ds_read_b128 v[192:195], v24 offset:0
    ds_read_b128 v[196:199], v24 offset:2048
    ds_read_b128 v[200:203], v24 offset:4096
    ds_read_b128 v[204:207], v24 offset:6144
    ds_read_b64_tr_b16 v[180:181], v21 offset:0
    ds_read_b64_tr_b16 v[182:183], v21 offset:1024
    ds_read_b64_tr_b16 v[184:185], v22 offset:0
    ds_read_b64_tr_b16 v[186:187], v22 offset:1024
    ds_read_b64_tr_b16 v[188:189], v23 offset:0
    ds_read_b64_tr_b16 v[190:191], v23 offset:1024
    s_waitcnt lgkmcnt(6)
.p2align 3
g_cloop:
    v_mfma_f32_16x16x32_bf16 v[112:115], v[176:179], v[192:195], v[112:115]
    ds_read_b64_tr_b16 v[208:209], v20 offset:8192
    v_mfma_f32_16x16x32_bf16 v[116:119], v[176:179], v[196:199], v[116:119]
    ds_read_b64_tr_b16 v[210:211], v20 offset:9216
    v_mfma_f32_16x16x32_bf16 v[120:123], v[176:179], v[200:203], v[120:123]
    ds_read_b128 v[224:227], v25 offset:0
    v_mfma_f32_16x16x32_bf16 v[124:127], v[176:179], v[204:207], v[124:127]
    s_waitcnt lgkmcnt(3)
    ds_read_b128 v[228:231], v25 offset:2048
    v_mfma_f32_16x16x32_bf16 v[128:131], v[180:183], v[192:195], v[128:131]
    ds_read_b128 v[232:235], v25 offset:4096
    v_mfma_f32_16x16x32_bf16 v[132:135], v[180:183], v[196:199], v[132:135]
    ds_read_b128 v[236:239], v25 offset:6144
    v_mfma_f32_16x16x32_bf16 v[136:139], v[180:183], v[200:203], v[136:139]
    ds_read_b64_tr_b16 v[212:213], v21 offset:8192
    v_mfma_f32_16x16x32_bf16 v[140:143], v[180:183], v[204:207], v[140:143]
    ds_read_b64_tr_b16 v[214:215], v21 offset:9216
    v_mfma_f32_16x16x32_bf16 v[144:147], v[184:187], v[192:195], v[144:147]
    ds_read_b64_tr_b16 v[216:217], v22 offset:8192
    v_mfma_f32_16x16x32_bf16 v[148:151], v[184:187], v[196:199], v[148:151]
    ds_read_b64_tr_b16 v[218:219], v22 offset:9216
    v_mfma_f32_16x16x32_bf16 v[152:155], v[184:187], v[200:203], v[152:155]
    ds_read_b64_tr_b16 v[220:221], v23 offset:8192
    v_mfma_f32_16x16x32_bf16 v[156:159], v[184:187], v[204:207], v[156:159]
    ds_read_b64_tr_b16 v[222:223], v23 offset:9216
    v_mfma_f32_16x16x32_bf16 v[160:163], v[188:191], v[192:195], v[160:163]
    v_mfma_f32_16x16x32_bf16 v[164:167], v[188:191], v[196:199], v[164:167]
    v_mfma_f32_16x16x32_bf16 v[168:171], v[188:191], v[200:203], v[168:171]
    v_mfma_f32_16x16x32_bf16 v[172:175], v[188:191], v[204:207], v[172:175]
    s_waitcnt lgkmcnt(6)
    v_mfma_f32_16x16x32_bf16 v[112:115], v[208:211], v[224:227], v[112:115]
    v_mfma_f32_16x16x32_bf16 v[116:119], v[208:211], v[228:231], v[116:119]
    s_waitcnt lgkmcnt(0)
    s_barrier
    v_mfma_f32_16x16x32_bf16 v[120:123], v[208:211], v[232:235], v[120:123]
    ds_read_b64_tr_b16 v[176:177], v20 offset:16384
    v_mfma_f32_16x16x32_bf16 v[124:127], v[208:211], v[236:239], v[124:127]
    ds_read_b64_tr_b16 v[178:179], v20 offset:17408
    v_mfma_f32_16x16x32_bf16 v[128:131], v[212:215], v[224:227], v[128:131]
    ds_read_b128 v[192:195], v24 offset:16384
    v_mfma_f32_16x16x32_bf16 v[132:135], v[212:215], v[228:231], v[132:135]
    ds_read_b128 v[196:199], v24 offset:18432
    v_mfma_f32_16x16x32_bf16 v[136:139], v[212:215], v[232:235], v[136:139]
    ds_read_b128 v[200:203], v24 offset:20480
    v_mfma_f32_16x16x32_bf16 v[140:143], v[212:215], v[236:239], v[140:143]
    ds_read_b128 v[204:207], v24 offset:22528
    v_mfma_f32_16x16x32_bf16 v[144:147], v[216:219], v[224:227], v[144:147]
    ds_read_b64_tr_b16 v[180:181], v21 offset:16384
    v_mfma_f32_16x16x32_bf16 v[148:151], v[216:219], v[228:231], v[148:151]
    ds_read_b64_tr_b16 v[182:183], v21 offset:17408
    v_mfma_f32_16x16x32_bf16 v[152:155], v[216:219], v[232:235], v[152:155]
    ds_read_b64_tr_b16 v[184:185], v22 offset:16384
    v_mfma_f32_16x16x32_bf16 v[156:159], v[216:219], v[236:239], v[156:159]
    ds_read_b64_tr_b16 v[186:187], v22 offset:17408
    v_mfma_f32_16x16x32_bf16 v[160:163], v[220:223], v[224:227], v[160:163]
    ds_read_b64_tr_b16 v[188:189], v23 offset:16384
    v_mfma_f32_16x16x32_bf16 v[164:167], v[220:223], v[228:231], v[164:167]
    ds_read_b64_tr_b16 v[190:191], v23 offset:17408
    v_mfma_f32_16x16x32_bf16 v[168:171], v[220:223], v[232:235], v[168:171]
    v_mfma_f32_16x16x32_bf16 v[172:175], v[220:223], v[236:239], v[172:175]
    s_waitcnt lgkmcnt(6)
    v_mfma_f32_16x16x32_bf16 v[112:115], v[176:179], v[192:195], v[112:115]
    ds_read_b64_tr_b16 v[208:209], v20 offset:24576
    v_mfma_f32_16x16x32_bf16 v[116:119], v[176:179], v[196:199], v[116:119]
    ds_read_b64_tr_b16 v[210:211], v20 offset:25600
    v_mfma_f32_16x16x32_bf16 v[120:123], v[176:179], v[200:203], v[120:123]
    ds_read_b128 v[224:227], v25 offset:16384
    v_mfma_f32_16x16x32_bf16 v[124:127], v[176:179], v[204:207], v[124:127]
    s_waitcnt lgkmcnt(3)
    ds_read_b128 v[228:231], v25 offset:18432
    v_mfma_f32_16x16x32_bf16 v[128:131], v[180:183], v[192:195], v[128:131]
    ds_read_b128 v[232:235], v25 offset:20480
    v_mfma_f32_16x16x32_bf16 v[132:135], v[180:183], v[196:199], v[132:135]
    ds_read_b128 v[236:239], v25 offset:22528
    v_mfma_f32_16x16x32_bf16 v[136:139], v[180:183], v[200:203], v[136:139]
    ds_read_b64_tr_b16 v[212:213], v21 offset:24576
    v_mfma_f32_16x16x32_bf16 v[140:143], v[180:183], v[204:207], v[140:143]
    ds_read_b64_tr_b16 v[214:215], v21 offset:25600
    v_mfma_f32_16x16x32_bf16 v[144:147], v[184:187], v[192:195], v[144:147]
    ds_read_b64_tr_b16 v[216:217], v22 offset:24576
    v_mfma_f32_16x16x32_bf16 v[148:151], v[184:187], v[196:199], v[148:151]
    ds_read_b64_tr_b16 v[218:219], v22 offset:25600
    v_mfma_f32_16x16x32_bf16 v[152:155], v[184:187], v[200:203], v[152:155]
    ds_read_b64_tr_b16 v[220:221], v23 offset:24576
    v_mfma_f32_16x16x32_bf16 v[156:159], v[184:187], v[204:207], v[156:159]
    ds_read_b64_tr_b16 v[222:223], v23 offset:25600
    v_mfma_f32_16x16x32_bf16 v[160:163], v[188:191], v[192:195], v[160:163]
    v_xor_b32 v20, s3, v20
    v_mfma_f32_16x16x32_bf16 v[164:167], v[188:191], v[196:199], v[164:167]
    v_xor_b32 v24, s11, v24
    v_mfma_f32_16x16x32_bf16 v[168:171], v[188:191], v[200:203], v[168:171]
    v_xor_b32 v21, s3, v21
    v_mfma_f32_16x16x32_bf16 v[172:175], v[188:191], v[204:207], v[172:175]
    s_waitcnt lgkmcnt(6)
    v_xor_b32 v23, s3, v23
    v_mfma_f32_16x16x32_bf16 v[112:115], v[208:211], v[224:227], v[112:115]
    v_xor_b32 v22, s3, v22
    v_mfma_f32_16x16x32_bf16 v[116:119], v[208:211], v[228:231], v[116:119]
    s_waitcnt lgkmcnt(0)
    s_barrier
    v_mfma_f32_16x16x32_bf16 v[120:123], v[208:211], v[232:235], v[120:123]
    ds_read_b64_tr_b16 v[176:177], v20 offset:0
    v_mfma_f32_16x16x32_bf16 v[124:127], v[208:211], v[236:239], v[124:127]
    ds_read_b64_tr_b16 v[178:179], v20 offset:1024
    v_mfma_f32_16x16x32_bf16 v[128:131], v[212:215], v[224:227], v[128:131]
    ds_read_b128 v[192:195], v24 offset:0
    v_mfma_f32_16x16x32_bf16 v[132:135], v[212:215], v[228:231], v[132:135]
    ds_read_b128 v[196:199], v24 offset:2048
    v_mfma_f32_16x16x32_bf16 v[136:139], v[212:215], v[232:235], v[136:139]
    ds_read_b128 v[200:203], v24 offset:4096
    v_mfma_f32_16x16x32_bf16 v[140:143], v[212:215], v[236:239], v[140:143]
    ds_read_b128 v[204:207], v24 offset:6144
    v_mfma_f32_16x16x32_bf16 v[144:147], v[216:219], v[224:227], v[144:147]
    ds_read_b64_tr_b16 v[180:181], v21 offset:0
    v_mfma_f32_16x16x32_bf16 v[148:151], v[216:219], v[228:231], v[148:151]
    ds_read_b64_tr_b16 v[182:183], v21 offset:1024
    v_mfma_f32_16x16x32_bf16 v[152:155], v[216:219], v[232:235], v[152:155]
    ds_read_b64_tr_b16 v[184:185], v22 offset:0
    v_mfma_f32_16x16x32_bf16 v[156:159], v[216:219], v[236:239], v[156:159]
    ds_read_b64_tr_b16 v[186:187], v22 offset:1024
    v_mfma_f32_16x16x32_bf16 v[160:163], v[220:223], v[224:227], v[160:163]
    ds_read_b64_tr_b16 v[188:189], v23 offset:0
    v_mfma_f32_16x16x32_bf16 v[164:167], v[220:223], v[228:231], v[164:167]
    ds_read_b64_tr_b16 v[190:191], v23 offset:1024
    v_mfma_f32_16x16x32_bf16 v[168:171], v[220:223], v[232:235], v[168:171]
    v_xor_b32 v25, s11, v25
    v_mfma_f32_16x16x32_bf16 v[172:175], v[220:223], v[236:239], v[172:175]
    s_waitcnt lgkmcnt(6)
    v_mfma_f32_16x16x32_bf16 v[112:115], v[176:179], v[192:195], v[112:115]
    ds_read_b64_tr_b16 v[208:209], v20 offset:8192
    v_mfma_f32_16x16x32_bf16 v[116:119], v[176:179], v[196:199], v[116:119]
    ds_read_b64_tr_b16 v[210:211], v20 offset:9216
    v_mfma_f32_16x16x32_bf16 v[120:123], v[176:179], v[200:203], v[120:123]
    ds_read_b128 v[224:227], v25 offset:0
    v_mfma_f32_16x16x32_bf16 v[124:127], v[176:179], v[204:207], v[124:127]
    s_waitcnt lgkmcnt(3)
    ds_read_b128 v[228:231], v25 offset:2048
    v_mfma_f32_16x16x32_bf16 v[128:131], v[180:183], v[192:195], v[128:131]
    ds_read_b128 v[232:235], v25 offset:4096
    v_mfma_f32_16x16x32_bf16 v[132:135], v[180:183], v[196:199], v[132:135]
    ds_read_b128 v[236:239], v25 offset:6144
    v_mfma_f32_16x16x32_bf16 v[136:139], v[180:183], v[200:203], v[136:139]
    ds_read_b64_tr_b16 v[212:213], v21 offset:8192
    v_mfma_f32_16x16x32_bf16 v[140:143], v[180:183], v[204:207], v[140:143]
    ds_read_b64_tr_b16 v[214:215], v21 offset:9216
    v_mfma_f32_16x16x32_bf16 v[144:147], v[184:187], v[192:195], v[144:147]
    ds_read_b64_tr_b16 v[216:217], v22 offset:8192
    v_mfma_f32_16x16x32_bf16 v[148:151], v[184:187], v[196:199], v[148:151]
    ds_read_b64_tr_b16 v[218:219], v22 offset:9216
    v_mfma_f32_16x16x32_bf16 v[152:155], v[184:187], v[200:203], v[152:155]
    ds_read_b64_tr_b16 v[220:221], v23 offset:8192
    v_mfma_f32_16x16x32_bf16 v[156:159], v[184:187], v[204:207], v[156:159]
    ds_read_b64_tr_b16 v[222:223], v23 offset:9216
    v_mfma_f32_16x16x32_bf16 v[160:163], v[188:191], v[192:195], v[160:163]
    v_mfma_f32_16x16x32_bf16 v[164:167], v[188:191], v[196:199], v[164:167]
    v_mfma_f32_16x16x32_bf16 v[168:171], v[188:191], v[200:203], v[168:171]
    v_mfma_f32_16x16x32_bf16 v[172:175], v[188:191], v[204:207], v[172:175]
    s_waitcnt lgkmcnt(6)
    v_mfma_f32_16x16x32_bf16 v[112:115], v[208:211], v[224:227], v[112:115]
    v_mfma_f32_16x16x32_bf16 v[116:119], v[208:211], v[228:231], v[116:119]
    s_waitcnt lgkmcnt(0)
    s_barrier
    v_mfma_f32_16x16x32_bf16 v[120:123], v[208:211], v[232:235], v[120:123]
    ds_read_b64_tr_b16 v[176:177], v20 offset:16384
    v_mfma_f32_16x16x32_bf16 v[124:127], v[208:211], v[236:239], v[124:127]
    ds_read_b64_tr_b16 v[178:179], v20 offset:17408
    v_mfma_f32_16x16x32_bf16 v[128:131], v[212:215], v[224:227], v[128:131]
    ds_read_b128 v[192:195], v24 offset:16384
    v_mfma_f32_16x16x32_bf16 v[132:135], v[212:215], v[228:231], v[132:135]
    ds_read_b128 v[196:199], v24 offset:18432
    v_mfma_f32_16x16x32_bf16 v[136:139], v[212:215], v[232:235], v[136:139]
    ds_read_b128 v[200:203], v24 offset:20480
    v_mfma_f32_16x16x32_bf16 v[140:143], v[212:215], v[236:239], v[140:143]
    ds_read_b128 v[204:207], v24 offset:22528
    v_mfma_f32_16x16x32_bf16 v[144:147], v[216:219], v[224:227], v[144:147]
    ds_read_b64_tr_b16 v[180:181], v21 offset:16384
    v_mfma_f32_16x16x32_bf16 v[148:151], v[216:219], v[228:231], v[148:151]
    ds_read_b64_tr_b16 v[182:183], v21 offset:17408
    v_mfma_f32_16x16x32_bf16 v[152:155], v[216:219], v[232:235], v[152:155]
    ds_read_b64_tr_b16 v[184:185], v22 offset:16384
    v_mfma_f32_16x16x32_bf16 v[156:159], v[216:219], v[236:239], v[156:159]
    ds_read_b64_tr_b16 v[186:187], v22 offset:17408
    v_mfma_f32_16x16x32_bf16 v[160:163], v[220:223], v[224:227], v[160:163]
    ds_read_b64_tr_b16 v[188:189], v23 offset:16384
    v_mfma_f32_16x16x32_bf16 v[164:167], v[220:223], v[228:231], v[164:167]
    ds_read_b64_tr_b16 v[190:191], v23 offset:17408
    v_mfma_f32_16x16x32_bf16 v[168:171], v[220:223], v[232:235], v[168:171]
    v_mfma_f32_16x16x32_bf16 v[172:175], v[220:223], v[236:239], v[172:175]
    s_waitcnt lgkmcnt(6)
    v_mfma_f32_16x16x32_bf16 v[112:115], v[176:179], v[192:195], v[112:115]
    ds_read_b64_tr_b16 v[208:209], v20 offset:24576
    v_mfma_f32_16x16x32_bf16 v[116:119], v[176:179], v[196:199], v[116:119]
    ds_read_b64_tr_b16 v[210:211], v20 offset:25600
    v_mfma_f32_16x16x32_bf16 v[120:123], v[176:179], v[200:203], v[120:123]
    ds_read_b128 v[224:227], v25 offset:16384
    v_mfma_f32_16x16x32_bf16 v[124:127], v[176:179], v[204:207], v[124:127]
    s_waitcnt lgkmcnt(3)
    ds_read_b128 v[228:231], v25 offset:18432
    v_mfma_f32_16x16x32_bf16 v[128:131], v[180:183], v[192:195], v[128:131]
    ds_read_b128 v[232:235], v25 offset:20480
    v_mfma_f32_16x16x32_bf16 v[132:135], v[180:183], v[196:199], v[132:135]
    ds_read_b128 v[236:239], v25 offset:22528
    v_mfma_f32_16x16x32_bf16 v[136:139], v[180:183], v[200:203], v[136:139]
    ds_read_b64_tr_b16 v[212:213], v21 offset:24576
    v_mfma_f32_16x16x32_bf16 v[140:143], v[180:183], v[204:207], v[140:143]
    ds_read_b64_tr_b16 v[214:215], v21 offset:25600
    v_mfma_f32_16x16x32_bf16 v[144:147], v[184:187], v[192:195], v[144:147]
    ds_read_b64_tr_b16 v[216:217], v22 offset:24576
    v_mfma_f32_16x16x32_bf16 v[148:151], v[184:187], v[196:199], v[148:151]
    ds_read_b64_tr_b16 v[218:219], v22 offset:25600
    v_mfma_f32_16x16x32_bf16 v[152:155], v[184:187], v[200:203], v[152:155]
    ds_read_b64_tr_b16 v[220:221], v23 offset:24576
    v_mfma_f32_16x16x32_bf16 v[156:159], v[184:187], v[204:207], v[156:159]
    ds_read_b64_tr_b16 v[222:223], v23 offset:25600
    v_mfma_f32_16x16x32_bf16 v[160:163], v[188:191], v[192:195], v[160:163]
    v_xor_b32 v20, s3, v20
    v_mfma_f32_16x16x32_bf16 v[164:167], v[188:191], v[196:199], v[164:167]
    v_xor_b32 v24, s11, v24
    v_mfma_f32_16x16x32_bf16 v[168:171], v[188:191], v[200:203], v[168:171]
    v_xor_b32 v21, s3, v21
    v_mfma_f32_16x16x32_bf16 v[172:175], v[188:191], v[204:207], v[172:175]
    s_waitcnt lgkmcnt(6)
    v_xor_b32 v23, s3, v23
    v_mfma_f32_16x16x32_bf16 v[112:115], v[208:211], v[224:227], v[112:115]
    s_cmp_eq_u32 s53, s5
    v_xor_b32 v22, s3, v22
    v_mfma_f32_16x16x32_bf16 v[116:119], v[208:211], v[228:231], v[116:119]
    s_waitcnt lgkmcnt(0)
    s_barrier
    s_cbranch_scc1 g_fp
g_fpd:
    v_mfma_f32_16x16x32_bf16 v[120:123], v[208:211], v[232:235], v[120:123]
    ds_read_b64_tr_b16 v[176:177], v20 offset:0
    v_mfma_f32_16x16x32_bf16 v[124:127], v[208:211], v[236:239], v[124:127]
    ds_read_b64_tr_b16 v[178:179], v20 offset:1024
    v_mfma_f32_16x16x32_bf16 v[128:131], v[212:215], v[224:227], v[128:131]
    ds_read_b128 v[192:195], v24 offset:0
    v_mfma_f32_16x16x32_bf16 v[132:135], v[212:215], v[228:231], v[132:135]
    ds_read_b128 v[196:199], v24 offset:2048
    v_mfma_f32_16x16x32_bf16 v[136:139], v[212:215], v[232:235], v[136:139]
    ds_read_b128 v[200:203], v24 offset:4096
    v_mfma_f32_16x16x32_bf16 v[140:143], v[212:215], v[236:239], v[140:143]
    ds_read_b128 v[204:207], v24 offset:6144
    v_mfma_f32_16x16x32_bf16 v[144:147], v[216:219], v[224:227], v[144:147]
    ds_read_b64_tr_b16 v[180:181], v21 offset:0
    v_mfma_f32_16x16x32_bf16 v[148:151], v[216:219], v[228:231], v[148:151]
    ds_read_b64_tr_b16 v[182:183], v21 offset:1024
    v_mfma_f32_16x16x32_bf16 v[152:155], v[216:219], v[232:235], v[152:155]
    ds_read_b64_tr_b16 v[184:185], v22 offset:0
    v_mfma_f32_16x16x32_bf16 v[156:159], v[216:219], v[236:239], v[156:159]
    ds_read_b64_tr_b16 v[186:187], v22 offset:1024
    v_mfma_f32_16x16x32_bf16 v[160:163], v[220:223], v[224:227], v[160:163]
    ds_read_b64_tr_b16 v[188:189], v23 offset:0
    v_mfma_f32_16x16x32_bf16 v[164:167], v[220:223], v[228:231], v[164:167]
    ds_read_b64_tr_b16 v[190:191], v23 offset:1024
    s_add_u32 s53, s53, 1
    v_mfma_f32_16x16x32_bf16 v[168:171], v[220:223], v[232:235], v[168:171]
    s_cmp_lt_u32 s53, 4
    v_xor_b32 v25, s11, v25
    v_mfma_f32_16x16x32_bf16 v[172:175], v[220:223], v[236:239], v[172:175]
    s_waitcnt lgkmcnt(6)
    s_cbranch_scc1 g_cloop
g_cend:
    s_cmp_lg_u32 s9, 0
    s_cbranch_scc1 c_epilogue
    ds_read_b96 v[4:6], v7
    v_pk_mul_f32 v[112:113], v[112:113], s[24:25]
    v_pk_mul_f32 v[114:115], v[114:115], s[24:25]
    v_pk_mul_f32 v[128:129], v[128:129], s[24:25]
    v_pk_mul_f32 v[130:131], v[130:131], s[24:25]
    v_cvt_pk_bf16_f32 v208, v112, v113
    v_cvt_pk_bf16_f32 v210, v128, v129
    v_cvt_pk_bf16_f32 v209, v114, v115
    v_cvt_pk_bf16_f32 v211, v130, v131
    v_permlane16_swap_b32 v208, v210
    s_nop 0
    v_permlane16_swap_b32 v209, v211
    buffer_store_dwordx4 v[208:211], v26, s[60:63], s16 offen offset:0
    v_pk_mul_f32 v[116:117], v[116:117], s[24:25]
    v_pk_mul_f32 v[118:119], v[118:119], s[24:25]
    v_pk_mul_f32 v[132:133], v[132:133], s[24:25]
    v_pk_mul_f32 v[134:135], v[134:135], s[24:25]
    v_cvt_pk_bf16_f32 v212, v116, v117
    v_cvt_pk_bf16_f32 v214, v132, v133
    v_cvt_pk_bf16_f32 v213, v118, v119
    v_cvt_pk_bf16_f32 v215, v134, v135
    v_permlane16_swap_b32 v212, v214
    s_nop 0
    v_permlane16_swap_b32 v213, v215
    buffer_store_dwordx4 v[212:215], v26, s[60:63], s16 offen offset:256
    v_pk_mul_f32 v[120:121], v[120:121], s[24:25]
    v_pk_mul_f32 v[122:123], v[122:123], s[24:25]
    v_pk_mul_f32 v[136:137], v[136:137], s[24:25]
    v_pk_mul_f32 v[138:139], v[138:139], s[24:25]
    v_cvt_pk_bf16_f32 v216, v120, v121
    v_cvt_pk_bf16_f32 v218, v136, v137
    v_cvt_pk_bf16_f32 v217, v122, v123
    v_cvt_pk_bf16_f32 v219, v138, v139
    v_permlane16_swap_b32 v216, v218
    s_nop 0
    v_permlane16_swap_b32 v217, v219
    buffer_store_dwordx4 v[216:219], v26, s[60:63], s17 offen offset:0
    v_pk_mul_f32 v[124:125], v[124:125], s[24:25]
    v_pk_mul_f32 v[126:127], v[126:127], s[24:25]
    v_pk_mul_f32 v[140:141], v[140:141], s[24:25]
    v_pk_mul_f32 v[142:143], v[142:143], s[24:25]
    v_cvt_pk_bf16_f32 v220, v124, v125
    v_cvt_pk_bf16_f32 v222, v140, v141
    v_cvt_pk_bf16_f32 v221, v126, v127
    v_cvt_pk_bf16_f32 v223, v142, v143
    v_permlane16_swap_b32 v220, v222
    s_nop 0
    v_permlane16_swap_b32 v221, v223
    buffer_store_dwordx4 v[220:223], v26, s[60:63], s17 offen offset:256
    v_pk_mul_f32 v[144:145], v[144:145], s[24:25]
    v_pk_mul_f32 v[146:147], v[146:147], s[24:25]
    v_pk_mul_f32 v[160:161], v[160:161], s[24:25]
    v_pk_mul_f32 v[162:163], v[162:163], s[24:25]
    v_cvt_pk_bf16_f32 v224, v144, v145
    v_cvt_pk_bf16_f32 v226, v160, v161
    v_cvt_pk_bf16_f32 v225, v146, v147
    v_cvt_pk_bf16_f32 v227, v162, v163
    v_permlane16_swap_b32 v224, v226
    s_nop 0
    v_permlane16_swap_b32 v225, v227
    buffer_store_dwordx4 v[224:227], v26, s[60:63], s16 offen offset:2048
    v_pk_mul_f32 v[148:149], v[148:149], s[24:25]
    v_pk_mul_f32 v[150:151], v[150:151], s[24:25]
    v_pk_mul_f32 v[164:165], v[164:165], s[24:25]
    v_pk_mul_f32 v[166:167], v[166:167], s[24:25]
    v_cvt_pk_bf16_f32 v228, v148, v149
    v_cvt_pk_bf16_f32 v230, v164, v165
    v_cvt_pk_bf16_f32 v229, v150, v151
    v_cvt_pk_bf16_f32 v231, v166, v167
    v_permlane16_swap_b32 v228, v230
    s_nop 0
    v_permlane16_swap_b32 v229, v231
    buffer_store_dwordx4 v[228:231], v26, s[60:63], s16 offen offset:2304
    v_pk_mul_f32 v[152:153], v[152:153], s[24:25]
    v_pk_mul_f32 v[154:155], v[154:155], s[24:25]
    v_pk_mul_f32 v[168:169], v[168:169], s[24:25]
    v_pk_mul_f32 v[170:171], v[170:171], s[24:25]
    v_cvt_pk_bf16_f32 v232, v152, v153
    v_cvt_pk_bf16_f32 v234, v168, v169
    v_cvt_pk_bf16_f32 v233, v154, v155
    v_cvt_pk_bf16_f32 v235, v170, v171
    v_permlane16_swap_b32 v232, v234
    s_nop 0
    v_permlane16_swap_b32 v233, v235
    buffer_store_dwordx4 v[232:235], v26, s[60:63], s17 offen offset:2048
    v_pk_mul_f32 v[156:157], v[156:157], s[24:25]
    v_pk_mul_f32 v[158:159], v[158:159], s[24:25]
    v_pk_mul_f32 v[172:173], v[172:173], s[24:25]
    v_pk_mul_f32 v[174:175], v[174:175], s[24:25]
    v_cvt_pk_bf16_f32 v236, v156, v157
    v_cvt_pk_bf16_f32 v238, v172, v173
    v_cvt_pk_bf16_f32 v237, v158, v159
    v_cvt_pk_bf16_f32 v239, v174, v175
    v_permlane16_swap_b32 v236, v238
    s_nop 0
    v_permlane16_swap_b32 v237, v239
    buffer_store_dwordx4 v[236:239], v26, s[60:63], s17 offen offset:2304
    s_waitcnt lgkmcnt(0)
    v_readfirstlane_b32 s14, v4
    v_readfirstlane_b32 s15, v5
    v_readfirstlane_b32 s26, v6
    v_mov_b32 v6, 0
    s_cmp_eq_u32 s26, 0
    s_mov_b64 exec, 1
    s_waitcnt vmcnt(0)
    s_cbranch_scc1 fq_s
    buffer_store_dwordx2 v[4:5], v6, s[64:67], s18 offen
fq_d:
    s_mov_b64 exec, -1
    s_barrier
    ds_read_b128 v[176:179], v8 offset:0
    ds_read_b128 v[180:183], v9 offset:0
    ds_read_b128 v[184:187], v10 offset:0
    ds_read_b128 v[188:191], v11 offset:0
    ds_read_b128 v[192:195], v12 offset:0
    ds_read_b128 v[196:199], v13 offset:0
    ds_read_b128 v[200:203], v14 offset:0
    ds_read_b128 v[204:207], v15 offset:0
    s_mov_b32 s12, 0
a_pollq:
    buffer_load_dwordx2 v[2:3], v28, s[64:67], s19 offen sc1
    s_add_u32 s12, s12, 1
    s_cmp_gt_u32 s12, 262144
    s_cbranch_scc1 a_pollq_x
    s_waitcnt vmcnt(0)
    v_cmp_ne_u64 vcc, s[14:15], v[2:3]
    s_cmp_lg_u64 vcc, 0
    s_cbranch_scc1 a_pollq
a_pollq_x:
    s_cmp_eq_u32 s26, 0
    s_cbranch_scc1 a_acq_s
a_acq_d:
    buffer_load_dwordx4 v[112:115], v27, s[60:63], s20 offen offset:0 sc1
    buffer_load_dwordx4 v[116:119], v27, s[60:63], s20 offen offset:1024 sc1
    buffer_load_dwordx4 v[120:123], v27, s[60:63], s20 offen offset:2048 sc1
    buffer_load_dwordx4 v[124:127], v27, s[60:63], s20 offen offset:3072 sc1
    buffer_load_dwordx4 v[128:131], v27, s[60:63], s21 offen offset:0 sc1
    buffer_load_dwordx4 v[132:135], v27, s[60:63], s21 offen offset:1024 sc1
    buffer_load_dwordx4 v[136:139], v27, s[60:63], s21 offen offset:2048 sc1
    buffer_load_dwordx4 v[140:143], v27, s[60:63], s21 offen offset:3072 sc1
    s_barrier
a_start:
    s_waitcnt lgkmcnt(0)
    s_mov_b32 s53, 0
    s_waitcnt vmcnt(7)
    v_mfma_f32_32x32x16_bf16 v[144:159], v[176:179], v[112:115], v[96:111]
    s_waitcnt vmcnt(6)
    v_mfma_f32_32x32x16_bf16 v[144:159], v[180:183], v[116:119], v[144:159]
    ds_read_b128 v[176:179], v8 offset:8192
    s_waitcnt vmcnt(5)
    v_mfma_f32_32x32x16_bf16 v[144:159], v[184:187], v[120:123], v[144:159]
    ds_read_b128 v[180:183], v9 offset:8192
    s_waitcnt vmcnt(4)
    v_mfma_f32_32x32x16_bf16 v[144:159], v[188:191], v[124:127], v[144:159]
    ds_read_b128 v[184:187], v10 offset:8192
    s_waitcnt vmcnt(3)
    v_mfma_f32_32x32x16_bf16 v[144:159], v[192:195], v[128:131], v[144:159]
    ds_read_b128 v[188:191], v11 offset:8192
    s_waitcnt vmcnt(2)
    v_mfma_f32_32x32x16_bf16 v[144:159], v[196:199], v[132:135], v[144:159]
    ds_read_b128 v[192:195], v12 offset:8192
    s_waitcnt vmcnt(1)
    v_mfma_f32_32x32x16_bf16 v[144:159], v[200:203], v[136:139], v[144:159]
    ds_read_b128 v[196:199], v13 offset:8192
    s_waitcnt vmcnt(0)
    v_mfma_f32_32x32x16_bf16 v[144:159], v[204:207], v[140:143], v[144:159]
    ds_read_b128 v[200:203], v14 offset:8192
    ds_read_b128 v[204:207], v15 offset:8192
    s_nop 7
    s_nop 2
    v_exp_f32 v144, v144
    v_exp_f32 v145, v145
    v_exp_f32 v146, v146
    v_exp_f32 v147, v147
    v_exp_f32 v148, v148
    v_exp_f32 v149, v149
    v_add_f32 v30, v30, v144
    v_add_f32 v30, v30, v145
    v_cvt_pk_bf16_f32 v240, v144, v145
    v_add_f32 v30, v30, v146
    v_add_f32 v30, v30, v147
    v_cvt_pk_bf16_f32 v241, v146, v147
    v_add_f32 v30, v30, v148
    s_waitcnt lgkmcnt(0)
.p2align 3
a_loop:
    v_mfma_f32_32x32x16_bf16 v[160:175], v[176:179], v[112:115], v[96:111]
    s_barrier
    ds_read_b64_tr_b16 v[208:209], v16 offset:0
    ds_read_b64_tr_b16 v[210:211], v16 offset:2048
    v_exp_f32 v150, v150
    v_add_f32 v30, v30, v149
    v_cvt_pk_bf16_f32 v242, v148, v149
    v_mfma_f32_32x32x16_bf16 v[160:175], v[180:183], v[116:119], v[160:175]
    ds_read_b64_tr_b16 v[212:213], v17 offset:0
    ds_read_b64_tr_b16 v[214:215], v17 offset:2048
    v_exp_f32 v151, v151
    v_add_f32 v30, v30, v150
    v_mfma_f32_32x32x16_bf16 v[160:175], v[184:187], v[120:123], v[160:175]
    ds_read_b64_tr_b16 v[216:217], v18 offset:0
    ds_read_b64_tr_b16 v[218:219], v18 offset:2048
    v_exp_f32 v152, v152
    v_add_f32 v30, v30, v151
    v_cvt_pk_bf16_f32 v243, v150, v151
    v_mfma_f32_32x32x16_bf16 v[160:175], v[188:191], v[124:127], v[160:175]
    ds_read_b64_tr_b16 v[220:221], v19 offset:0
    ds_read_b64_tr_b16 v[222:223], v19 offset:2048
    v_exp_f32 v153, v153
    v_add_f32 v30, v30, v152
    v_mfma_f32_32x32x16_bf16 v[160:175], v[192:195], v[128:131], v[160:175]
    ds_read_b64_tr_b16 v[224:225], v16 offset:4096
    ds_read_b64_tr_b16 v[226:227], v16 offset:6144
    v_exp_f32 v154, v154
    v_add_f32 v30, v30, v153
    v_cvt_pk_bf16_f32 v244, v152, v153
    v_mfma_f32_32x32x16_bf16 v[160:175], v[196:199], v[132:135], v[160:175]
    ds_read_b64_tr_b16 v[228:229], v17 offset:4096
    ds_read_b64_tr_b16 v[230:231], v17 offset:6144
    v_exp_f32 v155, v155
    v_add_f32 v30, v30, v154
    v_mfma_f32_32x32x16_bf16 v[160:175], v[200:203], v[136:139], v[160:175]
    ds_read_b64_tr_b16 v[232:233], v18 offset:4096
    ds_read_b64_tr_b16 v[234:235], v18 offset:6144
    v_exp_f32 v156, v156
    v_add_f32 v30, v30, v155
    v_cvt_pk_bf16_f32 v245, v154, v155
    v_mfma_f32_32x32x16_bf16 v[160:175], v[204:207], v[140:143], v[160:175]
    s_waitcnt lgkmcnt(6)
    ds_read_b64_tr_b16 v[236:237], v19 offset:4096
    ds_read_b64_tr_b16 v[238:239], v19 offset:6144
    v_exp_f32 v157, v157
    v_add_f32 v30, v30, v156
    v_mfma_f32_32x32x16_bf16 v[32:47], v[208:211], v[240:243], v[32:47]
    ds_read_b128 v[176:179], v8 offset:16384
    ds_read_b128 v[180:183], v9 offset:16384
    v_exp_f32 v158, v158
    v_add_f32 v30, v30, v157
    v_cvt_pk_bf16_f32 v246, v156, v157
    v_mfma_f32_32x32x16_bf16 v[48:63], v[212:215], v[240:243], v[48:63]
    ds_read_b128 v[184:187], v10 offset:16384
    ds_read_b128 v[188:191], v11 offset:16384
    v_exp_f32 v159, v159
    v_add_f32 v30, v30, v158
    v_mfma_f32_32x32x16_bf16 v[64:79], v[216:219], v[240:243], v[64:79]
    ds_read_b128 v[192:195], v12 offset:16384
    ds_read_b128 v[196:199], v13 offset:16384
    v_exp_f32 v160, v160
    v_add_f32 v30, v30, v159
    v_cvt_pk_bf16_f32 v247, v158, v159
    v_mfma_f32_32x32x16_bf16 v[80:95], v[220:223], v[240:243], v[80:95]
    s_waitcnt lgkmcnt(6)
    ds_read_b128 v[200:203], v14 offset:16384
    ds_read_b128 v[204:207], v15 offset:16384
    v_exp_f32 v161, v161
    v_add_f32 v30, v30, v160
    v_mfma_f32_32x32x16_bf16 v[32:47], v[224:227], v[244:247], v[32:47]
    v_exp_f32 v162, v162
    v_add_f32 v30, v30, v161
    v_cvt_pk_bf16_f32 v240, v160, v161
    v_mfma_f32_32x32x16_bf16 v[48:63], v[228:231], v[244:247], v[48:63]
    v_exp_f32 v163, v163
    v_add_f32 v30, v30, v162
    v_mfma_f32_32x32x16_bf16 v[64:79], v[232:235], v[244:247], v[64:79]
    v_exp_f32 v164, v164
    v_add_f32 v30, v30, v163
    v_cvt_pk_bf16_f32 v241, v162, v163
    v_mfma_f32_32x32x16_bf16 v[80:95], v[236:239], v[244:247], v[80:95]
    s_waitcnt lgkmcnt(0)
    v_exp_f32 v165, v165
    v_add_f32 v30, v30, v164
    v_mfma_f32_32x32x16_bf16 v[144:159], v[176:179], v[112:115], v[96:111]
    ds_read_b64_tr_b16 v[208:209], v16 offset:8192
    ds_read_b64_tr_b16 v[210:211], v16 offset:10240
    v_exp_f32 v166, v166
    v_add_f32 v30, v30, v165
    v_cvt_pk_bf16_f32 v242, v164, v165
    v_mfma_f32_32x32x16_bf16 v[144:159], v[180:183], v[116:119], v[144:159]
    ds_read_b64_tr_b16 v[212:213], v17 offset:8192
    ds_read_b64_tr_b16 v[214:215], v17 offset:10240
    v_exp_f32 v167, v167
    v_add_f32 v30, v30, v166
    v_mfma_f32_32x32x16_bf16 v[144:159], v[184:187], v[120:123], v[144:159]
    ds_read_b64_tr_b16 v[216:217], v18 offset:8192
    ds_read_b64_tr_b16 v[218:219], v18 offset:10240
    v_exp_f32 v168, v168
    v_add_f32 v30, v30, v167
    v_cvt_pk_bf16_f32 v243, v166, v167
    v_mfma_f32_32x32x16_bf16 v[144:159], v[188:191], v[124:127], v[144:159]
    ds_read_b64_tr_b16 v[220:221], v19 offset:8192
    ds_read_b64_tr_b16 v[222:223], v19 offset:10240
    v_exp_f32 v169, v169
    v_add_f32 v30, v30, v168
    v_mfma_f32_32x32x16_bf16 v[144:159], v[192:195], v[128:131], v[144:159]
    ds_read_b64_tr_b16 v[224:225], v16 offset:12288
    ds_read_b64_tr_b16 v[226:227], v16 offset:14336
    v_exp_f32 v170, v170
    v_add_f32 v30, v30, v169
    v_cvt_pk_bf16_f32 v244, v168, v169
    v_mfma_f32_32x32x16_bf16 v[144:159], v[196:199], v[132:135], v[144:159]
    ds_read_b64_tr_b16 v[228:229], v17 offset:12288
    ds_read_b64_tr_b16 v[230:231], v17 offset:14336
    v_exp_f32 v171, v171
    v_add_f32 v30, v30, v170
    v_mfma_f32_32x32x16_bf16 v[144:159], v[200:203], v[136:139], v[144:159]
    ds_read_b64_tr_b16 v[232:233], v18 offset:12288
    ds_read_b64_tr_b16 v[234:235], v18 offset:14336
    v_exp_f32 v172, v172
    v_add_f32 v30, v30, v171
    v_cvt_pk_bf16_f32 v245, v170, v171
    v_mfma_f32_32x32x16_bf16 v[144:159], v[204:207], v[140:143], v[144:159]
    s_waitcnt lgkmcnt(6)
    ds_read_b64_tr_b16 v[236:237], v19 offset:12288
    ds_read_b64_tr_b16 v[238:239], v19 offset:14336
    v_exp_f32 v173, v173
    v_add_f32 v30, v30, v172
    v_mfma_f32_32x32x16_bf16 v[32:47], v[208:211], v[240:243], v[32:47]
    ds_read_b128 v[176:179], v8 offset:24576
    ds_read_b128 v[180:183], v9 offset:24576
    v_exp_f32 v174, v174
    v_add_f32 v30, v30, v173
    v_cvt_pk_bf16_f32 v246, v172, v173
    v_mfma_f32_32x32x16_bf16 v[48:63], v[212:215], v[240:243], v[48:63]
    ds_read_b128 v[184:187], v10 offset:24576
    ds_read_b128 v[188:191], v11 offset:24576
    v_exp_f32 v175, v175
    v_add_f32 v30, v30, v174
    v_mfma_f32_32x32x16_bf16 v[64:79], v[216:219], v[240:243], v[64:79]
    ds_read_b128 v[192:195], v12 offset:24576
    ds_read_b128 v[196:199], v13 offset:24576
    v_exp_f32 v144, v144
    v_add_f32 v30, v30, v175
    v_cvt_pk_bf16_f32 v247, v174, v175
    v_mfma_f32_32x32x16_bf16 v[80:95], v[220:223], v[240:243], v[80:95]
    s_waitcnt lgkmcnt(6)
    ds_read_b128 v[200:203], v14 offset:24576
    ds_read_b128 v[204:207], v15 offset:24576
    v_exp_f32 v145, v145
    v_add_f32 v30, v30, v144
    v_mfma_f32_32x32x16_bf16 v[32:47], v[224:227], v[244:247], v[32:47]
    v_exp_f32 v146, v146
    v_add_f32 v30, v30, v145
    v_cvt_pk_bf16_f32 v240, v144, v145
    v_xor_b32 v8, 0x10000, v8
    v_mfma_f32_32x32x16_bf16 v[48:63], v[228:231], v[244:247], v[48:63]
    v_exp_f32 v147, v147
    v_add_f32 v30, v30, v146
    v_xor_b32 v10, 0x10000, v10
    v_mfma_f32_32x32x16_bf16 v[64:79], v[232:235], v[244:247], v[64:79]
    v_exp_f32 v148, v148
    v_add_f32 v30, v30, v147
    v_cvt_pk_bf16_f32 v241, v146, v147
    v_xor_b32 v12, 0x10000, v12
    v_mfma_f32_32x32x16_bf16 v[80:95], v[236:239], v[244:247], v[80:95]
    s_waitcnt lgkmcnt(0)
    v_exp_f32 v149, v149
    v_add_f32 v30, v30, v148
    v_xor_b32 v14, 0x10000, v14
    v_mfma_f32_32x32x16_bf16 v[160:175], v[176:179], v[112:115], v[96:111]
    s_barrier
    ds_read_b64_tr_b16 v[208:209], v16 offset:16384
    ds_read_b64_tr_b16 v[210:211], v16 offset:18432
    v_exp_f32 v150, v150
    v_add_f32 v30, v30, v149
    v_cvt_pk_bf16_f32 v242, v148, v149
    v_mfma_f32_32x32x16_bf16 v[160:175], v[180:183], v[116:119], v[160:175]
    ds_read_b64_tr_b16 v[212:213], v17 offset:16384
    ds_read_b64_tr_b16 v[214:215], v17 offset:18432
    v_exp_f32 v151, v151
    v_add_f32 v30, v30, v150
    v_xor_b32 v9, 0x10000, v9
    v_mfma_f32_32x32x16_bf16 v[160:175], v[184:187], v[120:123], v[160:175]
    ds_read_b64_tr_b16 v[216:217], v18 offset:16384
    ds_read_b64_tr_b16 v[218:219], v18 offset:18432
    v_exp_f32 v152, v152
    v_add_f32 v30, v30, v151
    v_cvt_pk_bf16_f32 v243, v150, v151
    v_mfma_f32_32x32x16_bf16 v[160:175], v[188:191], v[124:127], v[160:175]
    ds_read_b64_tr_b16 v[220:221], v19 offset:16384
    ds_read_b64_tr_b16 v[222:223], v19 offset:18432
    v_exp_f32 v153, v153
    v_add_f32 v30, v30, v152
    v_xor_b32 v11, 0x10000, v11
    v_mfma_f32_32x32x16_bf16 v[160:175], v[192:195], v[128:131], v[160:175]
    ds_read_b64_tr_b16 v[224:225], v16 offset:20480
    ds_read_b64_tr_b16 v[226:227], v16 offset:22528
    v_exp_f32 v154, v154
    v_add_f32 v30, v30, v153
    v_cvt_pk_bf16_f32 v244, v152, v153
    v_mfma_f32_32x32x16_bf16 v[160:175], v[196:199], v[132:135], v[160:175]
    ds_read_b64_tr_b16 v[228:229], v17 offset:20480
    ds_read_b64_tr_b16 v[230:231], v17 offset:22528
    v_exp_f32 v155, v155
    v_add_f32 v30, v30, v154
    v_xor_b32 v13, 0x10000, v13
    v_mfma_f32_32x32x16_bf16 v[160:175], v[200:203], v[136:139], v[160:175]
    ds_read_b64_tr_b16 v[232:233], v18 offset:20480
    ds_read_b64_tr_b16 v[234:235], v18 offset:22528
    v_exp_f32 v156, v156
    v_add_f32 v30, v30, v155
    v_cvt_pk_bf16_f32 v245, v154, v155
    v_mfma_f32_32x32x16_bf16 v[160:175], v[204:207], v[140:143], v[160:175]
    s_waitcnt lgkmcnt(6)
    ds_read_b64_tr_b16 v[236:237], v19 offset:20480
    ds_read_b64_tr_b16 v[238:239], v19 offset:22528
    v_exp_f32 v157, v157
    v_add_f32 v30, v30, v156
    v_xor_b32 v15, 0x10000, v15
    v_mfma_f32_32x32x16_bf16 v[32:47], v[208:211], v[240:243], v[32:47]
    ds_read_b128 v[176:179], v8 offset:0
    ds_read_b128 v[180:183], v9 offset:0
    v_exp_f32 v158, v158
    v_add_f32 v30, v30, v157
    v_cvt_pk_bf16_f32 v246, v156, v157
    v_mfma_f32_32x32x16_bf16 v[48:63], v[212:215], v[240:243], v[48:63]
    ds_read_b128 v[184:187], v10 offset:0
    ds_read_b128 v[188:191], v11 offset:0
    v_exp_f32 v159, v159
    v_add_f32 v30, v30, v158
    v_mfma_f32_32x32x16_bf16 v[64:79], v[216:219], v[240:243], v[64:79]
    ds_read_b128 v[192:195], v12 offset:0
    ds_read_b128 v[196:199], v13 offset:0
    v_exp_f32 v160, v160
    v_add_f32 v30, v30, v159
    v_cvt_pk_bf16_f32 v247, v158, v159
    v_mfma_f32_32x32x16_bf16 v[80:95], v[220:223], v[240:243], v[80:95]
    s_waitcnt lgkmcnt(6)
    ds_read_b128 v[200:203], v14 offset:0
    ds_read_b128 v[204:207], v15 offset:0
    v_exp_f32 v161, v161
    v_add_f32 v30, v30, v160
    v_mfma_f32_32x32x16_bf16 v[32:47], v[224:227], v[244:247], v[32:47]
    v_exp_f32 v162, v162
    v_add_f32 v30, v30, v161
    v_cvt_pk_bf16_f32 v240, v160, v161
    v_mfma_f32_32x32x16_bf16 v[48:63], v[228:231], v[244:247], v[48:63]
    v_exp_f32 v163, v163
    v_add_f32 v30, v30, v162
    v_mfma_f32_32x32x16_bf16 v[64:79], v[232:235], v[244:247], v[64:79]
    s_cmp_eq_u32 s53, s10
    v_exp_f32 v164, v164
    v_add_f32 v30, v30, v163
    v_cvt_pk_bf16_f32 v241, v162, v163
    v_mfma_f32_32x32x16_bf16 v[80:95], v[236:239], v[244:247], v[80:95]
    s_waitcnt lgkmcnt(0)
    v_exp_f32 v165, v165
    v_add_f32 v30, v30, v164
    s_cbranch_scc1 a_tail
    v_mfma_f32_32x32x16_bf16 v[144:159], v[176:179], v[112:115], v[96:111]
    ds_read_b64_tr_b16 v[208:209], v16 offset:24576
    ds_read_b64_tr_b16 v[210:211], v16 offset:26624
    v_exp_f32 v166, v166
    v_add_f32 v30, v30, v165
    v_cvt_pk_bf16_f32 v242, v164, v165
    v_mfma_f32_32x32x16_bf16 v[144:159], v[180:183], v[116:119], v[144:159]
    ds_read_b64_tr_b16 v[212:213], v17 offset:24576
    ds_read_b64_tr_b16 v[214:215], v17 offset:26624
    v_exp_f32 v167, v167
    v_add_f32 v30, v30, v166
    v_mfma_f32_32x32x16_bf16 v[144:159], v[184:187], v[120:123], v[144:159]
    ds_read_b64_tr_b16 v[216:217], v18 offset:24576
    ds_read_b64_tr_b16 v[218:219], v18 offset:26624
    v_exp_f32 v168, v168
    v_add_f32 v30, v30, v167
    v_cvt_pk_bf16_f32 v243, v166, v167
    v_mfma_f32_32x32x16_bf16 v[144:159], v[188:191], v[124:127], v[144:159]
    ds_read_b64_tr_b16 v[220:221], v19 offset:24576
    ds_read_b64_tr_b16 v[222:223], v19 offset:26624
    v_exp_f32 v169, v169
    v_add_f32 v30, v30, v168
    v_mfma_f32_32x32x16_bf16 v[144:159], v[192:195], v[128:131], v[144:159]
    ds_read_b64_tr_b16 v[224:225], v16 offset:28672
    ds_read_b64_tr_b16 v[226:227], v16 offset:30720
    v_exp_f32 v170, v170
    v_add_f32 v30, v30, v169
    v_cvt_pk_bf16_f32 v244, v168, v169
    v_mfma_f32_32x32x16_bf16 v[144:159], v[196:199], v[132:135], v[144:159]
    ds_read_b64_tr_b16 v[228:229], v17 offset:28672
    ds_read_b64_tr_b16 v[230:231], v17 offset:30720
    v_exp_f32 v171, v171
    v_add_f32 v30, v30, v170
    v_mfma_f32_32x32x16_bf16 v[144:159], v[200:203], v[136:139], v[144:159]
    ds_read_b64_tr_b16 v[232:233], v18 offset:28672
    ds_read_b64_tr_b16 v[234:235], v18 offset:30720
    v_exp_f32 v172, v172
    v_add_f32 v30, v30, v171
    v_cvt_pk_bf16_f32 v245, v170, v171
    v_mfma_f32_32x32x16_bf16 v[144:159], v[204:207], v[140:143], v[144:159]
    s_waitcnt lgkmcnt(6)
    ds_read_b64_tr_b16 v[236:237], v19 offset:28672
    ds_read_b64_tr_b16 v[238:239], v19 offset:30720
    v_exp_f32 v173, v173
    v_add_f32 v30, v30, v172
    v_mfma_f32_32x32x16_bf16 v[32:47], v[208:211], v[240:243], v[32:47]
    ds_read_b128 v[176:179], v8 offset:8192
    ds_read_b128 v[180:183], v9 offset:8192
    v_exp_f32 v174, v174
    v_add_f32 v30, v30, v173
    v_cvt_pk_bf16_f32 v246, v172, v173
    v_mfma_f32_32x32x16_bf16 v[48:63], v[212:215], v[240:243], v[48:63]
    ds_read_b128 v[184:187], v10 offset:8192
    ds_read_b128 v[188:191], v11 offset:8192
    v_exp_f32 v175, v175
    v_add_f32 v30, v30, v174
    v_mfma_f32_32x32x16_bf16 v[64:79], v[216:219], v[240:243], v[64:79]
    ds_read_b128 v[192:195], v12 offset:8192
    ds_read_b128 v[196:199], v13 offset:8192
    v_exp_f32 v144, v144
    v_add_f32 v30, v30, v175
    v_cvt_pk_bf16_f32 v247, v174, v175
    v_mfma_f32_32x32x16_bf16 v[80:95], v[220:223], v[240:243], v[80:95]
    s_waitcnt lgkmcnt(6)
    ds_read_b128 v[200:203], v14 offset:8192
    ds_read_b128 v[204:207], v15 offset:8192
    v_exp_f32 v145, v145
    v_add_f32 v30, v30, v144
    v_mfma_f32_32x32x16_bf16 v[32:47], v[224:227], v[244:247], v[32:47]
    v_exp_f32 v146, v146
    v_add_f32 v30, v30, v145
    v_cvt_pk_bf16_f32 v240, v144, v145
    v_xor_b32 v16, 0x10000, v16
    v_mfma_f32_32x32x16_bf16 v[48:63], v[228:231], v[244:247], v[48:63]
    v_exp_f32 v147, v147
    v_add_f32 v30, v30, v146
    v_xor_b32 v17, 0x10000, v17
    v_mfma_f32_32x32x16_bf16 v[64:79], v[232:235], v[244:247], v[64:79]
    s_add_u32 s53, s53, 1
    v_exp_f32 v148, v148
    v_add_f32 v30, v30, v147
    v_cvt_pk_bf16_f32 v241, v146, v147
    v_xor_b32 v18, 0x10000, v18
    v_mfma_f32_32x32x16_bf16 v[80:95], v[236:239], v[244:247], v[80:95]
    s_waitcnt lgkmcnt(0)
    v_exp_f32 v149, v149
    v_add_f32 v30, v30, v148
    v_xor_b32 v19, 0x10000, v19
    s_branch a_loop
a_tail:
    ds_read_b64_tr_b16 v[208:209], v16 offset:24576
    ds_read_b64_tr_b16 v[210:211], v16 offset:26624
    ds_read_b64_tr_b16 v[212:213], v17 offset:24576
    ds_read_b64_tr_b16 v[214:215], v17 offset:26624
    ds_read_b64_tr_b16 v[216:217], v18 offset:24576
    ds_read_b64_tr_b16 v[218:219], v18 offset:26624
    ds_read_b64_tr_b16 v[220:221], v19 offset:24576
    ds_read_b64_tr_b16 v[222:223], v19 offset:26624
    v_exp_f32 v166, v166
    v_exp_f32 v167, v167
    v_add_f32 v30, v30, v165
    v_cvt_pk_bf16_f32 v242, v164, v165
    v_add_f32 v30, v30, v166
    v_add_f32 v30, v30, v167
    v_cvt_pk_bf16_f32 v243, v166, v167
    ds_read_b64_tr_b16 v[224:225], v16 offset:28672
    ds_read_b64_tr_b16 v[226:227], v16 offset:30720
    ds_read_b64_tr_b16 v[228:229], v17 offset:28672
    ds_read_b64_tr_b16 v[230:231], v17 offset:30720
    ds_read_b64_tr_b16 v[232:233], v18 offset:28672
    ds_read_b64_tr_b16 v[234:235], v18 offset:30720
    ds_read_b64_tr_b16 v[236:237], v19 offset:28672
    ds_read_b64_tr_b16 v[238:239], v19 offset:30720
    s_lshl_b32 s52, s48, 2
    s_add_u32 s52, s52, 134144
    v_mov_b32 v3, s52
    v_mov_b32 v7, 134144
    s_mov_b32 s49, 0x28000000
    s_cmp_lg_u32 s8, 0
    s_waitcnt lgkmcnt(14)
    v_mfma_f32_32x32x16_bf16 v[32:47], v[208:211], v[240:243], v[32:47]
    v_exp_f32 v168, v168
    v_exp_f32 v169, v169
    s_nop 0
    v_add_f32 v30, v30, v168
    s_waitcnt lgkmcnt(12)
    v_mfma_f32_32x32x16_bf16 v[48:63], v[212:215], v[240:243], v[48:63]
    v_exp_f32 v170, v170
    v_exp_f32 v171, v171
    v_add_f32 v30, v30, v169
    v_cvt_pk_bf16_f32 v244, v168, v169
    v_add_f32 v30, v30, v170
    s_waitcnt lgkmcnt(10)
    v_mfma_f32_32x32x16_bf16 v[64:79], v[216:219], v[240:243], v[64:79]
    v_exp_f32 v172, v172
    v_exp_f32 v173, v173
    v_add_f32 v30, v30, v171
    v_cvt_pk_bf16_f32 v245, v170, v171
    v_add_f32 v30, v30, v172
    s_waitcnt lgkmcnt(8)
    v_mfma_f32_32x32x16_bf16 v[80:95], v[220:223], v[240:243], v[80:95]
    v_exp_f32 v174, v174
    v_exp_f32 v175, v175
    v_add_f32 v30, v30, v173
    v_cvt_pk_bf16_f32 v246, v172, v173
    v_add_f32 v30, v30, v174
    v_add_f32 v30, v30, v175
    v_cvt_pk_bf16_f32 v247, v174, v175
    s_waitcnt lgkmcnt(0)
    s_barrier
    s_cbranch_scc1 a_t2
    v_mfma_f32_32x32x16_bf16 v[32:47], v[224:227], v[244:247], v[32:47]
    ds_read_b32 v152, v253 offset:2048
    ds_read_b128 v[144:147], v252
    ds_read_b128 v[148:151], v252 offset:1024
    ds_read_b128 v[176:179], v251 offset:0
    v_mfma_f32_32x32x16_bf16 v[48:63], v[228:231], v[244:247], v[48:63]
    ds_read_b128 v[180:183], v251 offset:1024
    ds_read_b128 v[184:187], v251 offset:2048
    ds_read_b128 v[188:191], v251 offset:3072
    ds_read_b128 v[192:195], v251 offset:4096
    v_mfma_f32_32x32x16_bf16 v[64:79], v[232:235], v[244:247], v[64:79]
    ds_read_b128 v[196:199], v251 offset:5120
    ds_read_b128 v[200:203], v251 offset:6144
    ds_read_b128 v[204:207], v251 offset:7168
    v_mfma_f32_32x32x16_bf16 v[80:95], v[236:239], v[244:247], v[80:95]
    s_waitcnt lgkmcnt(10)
    v_add_f32 v30, v30, v152
    v_mov_b32 v1, v30
    s_nop 0
    s_waitcnt lgkmcnt(7)
    v_mfma_f32_32x32x16_bf16 v[32:47], v[144:147], v[176:179], v[32:47]
    v_permlane32_swap_b32 v30, v1
    s_nop 0
    v_add_f32 v30, v30, v1
    s_waitcnt lgkmcnt(6)
    v_mfma_f32_32x32x16_bf16 v[32:47], v[148:151], v[180:183], v[32:47]
    v_subrev_u32 v2, 0x2b800000, v30
    v_rcp_f32 v30, v30
    v_cmp_lt_u32 vcc, s49, v2
    s_waitcnt lgkmcnt(5)
    v_mfma_f32_32x32x16_bf16 v[48:63], v[144:147], v[184:187], v[48:63]
    s_cmp_lg_u64 vcc, 0
    s_cselect_b32 s50, 1, 0
    s_andn2_b32 s50, s50, s8
    v_mov_b32 v2, s50
    s_waitcnt lgkmcnt(0)
    v_mfma_f32_32x32x16_bf16 v[48:63], v[148:151], v[188:191], v[48:63]
    ds_write_b32 v3, v2
    s_cmp_lg_u32 s50, 0
    s_cbranch_scc1 a_nostore
    s_nop 3
    v_mul_f32 v32, v30, v32
    v_mul_f32 v33, v30, v33
    v_mul_f32 v34, v30, v34
    v_mul_f32 v35, v30, v35
    v_mul_f32 v36, v30, v36
    v_mul_f32 v37, v30, v37
    v_mfma_f32_32x32x16_bf16 v[64:79], v[144:147], v[192:195], v[64:79]
    v_mul_f32 v38, v30, v38
    v_mul_f32 v39, v30, v39
    v_cvt_pk_bf16_f32 v208, v32, v33
    v_cvt_pk_bf16_f32 v209, v34, v35
    v_cvt_pk_bf16_f32 v210, v36, v37
    v_cvt_pk_bf16_f32 v211, v38, v39
    buffer_store_dwordx4 v[208:211], v29, s[60:63], s20 offen offset:0
    v_mfma_f32_32x32x16_bf16 v[64:79], v[148:151], v[196:199], v[64:79]
    v_mul_f32 v40, v30, v40
    v_mul_f32 v41, v30, v41
    v_mul_f32 v42, v30, v42
    v_mul_f32 v43, v30, v43
    v_mul_f32 v44, v30, v44
    v_mul_f32 v45, v30, v45
    v_mul_f32 v46, v30, v46
    v_mfma_f32_32x32x16_bf16 v[80:95], v[144:147], v[200:203], v[80:95]
    v_mul_f32 v47, v30, v47
    v_cvt_pk_bf16_f32 v212, v40, v41
    v_cvt_pk_bf16_f32 v213, v42, v43
    v_cvt_pk_bf16_f32 v214, v44, v45
    v_cvt_pk_bf16_f32 v215, v46, v47
    buffer_store_dwordx4 v[212:215], v29, s[60:63], s20 offen offset:512
    v_mul_f32 v48, v30, v48
    v_mfma_f32_32x32x16_bf16 v[80:95], v[148:151], v[204:207], v[80:95]
    v_mul_f32 v49, v30, v49
    v_mul_f32 v50, v30, v50
    v_mul_f32 v51, v30, v51
    v_mul_f32 v52, v30, v52
    v_mul_f32 v53, v30, v53
    v_mul_f32 v54, v30, v54
    v_mul_f32 v55, v30, v55
    v_cvt_pk_bf16_f32 v216, v48, v49
    v_cvt_pk_bf16_f32 v217, v50, v51
    v_cvt_pk_bf16_f32 v218, v52, v53
    v_cvt_pk_bf16_f32 v219, v54, v55
    buffer_store_dwordx4 v[216:219], v29, s[60:63], s20 offen offset:1024
    v_mul_f32 v56, v30, v56
    v_mul_f32 v57, v30, v57
    v_mul_f32 v58, v30, v58
    v_mul_f32 v59, v30, v59
    v_mul_f32 v60, v30, v60
    v_mul_f32 v61, v30, v61
    v_mul_f32 v62, v30, v62
    v_mul_f32 v63, v30, v63
    v_cvt_pk_bf16_f32 v220, v56, v57
    v_cvt_pk_bf16_f32 v221, v58, v59
    v_cvt_pk_bf16_f32 v222, v60, v61
    v_cvt_pk_bf16_f32 v223, v62, v63
    buffer_store_dwordx4 v[220:223], v29, s[60:63], s20 offen offset:1536
    v_mul_f32 v64, v30, v64
    v_mul_f32 v65, v30, v65
    v_mul_f32 v66, v30, v66
    v_mul_f32 v67, v30, v67
    v_mul_f32 v68, v30, v68
    v_mul_f32 v69, v30, v69
    v_mul_f32 v70, v30, v70
    v_mul_f32 v71, v30, v71
    v_cvt_pk_bf16_f32 v224, v64, v65
    v_cvt_pk_bf16_f32 v225, v66, v67
    v_cvt_pk_bf16_f32 v226, v68, v69
    v_cvt_pk_bf16_f32 v227, v70, v71
    buffer_store_dwordx4 v[224:227], v29, s[60:63], s21 offen offset:0
    v_mul_f32 v72, v30, v72
    v_mul_f32 v73, v30, v73
    v_mul_f32 v74, v30, v74
    v_mul_f32 v75, v30, v75
    v_mul_f32 v76, v30, v76
    v_mul_f32 v77, v30, v77
    v_mul_f32 v78, v30, v78
    v_mul_f32 v79, v30, v79
    v_cvt_pk_bf16_f32 v228, v72, v73
    v_cvt_pk_bf16_f32 v229, v74, v75
    v_cvt_pk_bf16_f32 v230, v76, v77
    v_cvt_pk_bf16_f32 v231, v78, v79
    buffer_store_dwordx4 v[228:231], v29, s[60:63], s21 offen offset:512
    v_mul_f32 v80, v30, v80
    v_mul_f32 v81, v30, v81
    v_mul_f32 v82, v30, v82
    v_mul_f32 v83, v30, v83
    v_mul_f32 v84, v30, v84
    v_mul_f32 v85, v30, v85
    v_mul_f32 v86, v30, v86
    v_mul_f32 v87, v30, v87
    v_cvt_pk_bf16_f32 v232, v80, v81
    v_cvt_pk_bf16_f32 v233, v82, v83
    v_cvt_pk_bf16_f32 v234, v84, v85
    v_cvt_pk_bf16_f32 v235, v86, v87
    buffer_store_dwordx4 v[232:235], v29, s[60:63], s21 offen offset:1024
    v_mul_f32 v88, v30, v88
    v_mul_f32 v89, v30, v89
    v_mul_f32 v90, v30, v90
    v_mul_f32 v91, v30, v91
    v_mul_f32 v92, v30, v92
    v_mul_f32 v93, v30, v93
    v_mul_f32 v94, v30, v94
    v_mul_f32 v95, v30, v95
    v_cvt_pk_bf16_f32 v236, v88, v89
    v_cvt_pk_bf16_f32 v237, v90, v91
    v_cvt_pk_bf16_f32 v238, v92, v93
    v_cvt_pk_bf16_f32 v239, v94, v95
    buffer_store_dwordx4 v[236:239], v29, s[60:63], s21 offen offset:1536
    s_branch a_t4
a_t3:
    ds_write_b32 v3, v2
    s_or_b32 s50, s50, s6
    s_cbranch_scc1 a_nostore
    v_mul_f32 v32, v30, v32
    v_mul_f32 v33, v30, v33
    v_mul_f32 v34, v30, v34
    v_mul_f32 v35, v30, v35
    v_mul_f32 v36, v30, v36
    v_mul_f32 v37, v30, v37
    v_mul_f32 v38, v30, v38
    v_mul_f32 v39, v30, v39
    v_cvt_pk_bf16_f32 v208, v32, v33
    v_cvt_pk_bf16_f32 v209, v34, v35
    v_cvt_pk_bf16_f32 v210, v36, v37
    v_cvt_pk_bf16_f32 v211, v38, v39
    buffer_store_dwordx4 v[208:211], v29, s[60:63], s20 offen offset:0
    v_mul_f32 v40, v30, v40
    v_mul_f32 v41, v30, v41
    v_mul_f32 v42, v30, v42
    v_mul_f32 v43, v30, v43
    v_mul_f32 v44, v30, v44
    v_mul_f32 v45, v30, v45
    v_mul_f32 v46, v30, v46
    v_mul_f32 v47, v30, v47
    v_cvt_pk_bf16_f32 v212, v40, v41
    v_cvt_pk_bf16_f32 v213, v42, v43
    v_cvt_pk_bf16_f32 v214, v44, v45
    v_cvt_pk_bf16_f32 v215, v46, v47
    buffer_store_dwordx4 v[212:215], v29, s[60:63], s20 offen offset:512
    v_mul_f32 v48, v30, v48
    v_mul_f32 v49, v30, v49
    v_mul_f32 v50, v30, v50
    v_mul_f32 v51, v30, v51
    v_mul_f32 v52, v30, v52
    v_mul_f32 v53, v30, v53
    v_mul_f32 v54, v30, v54
    v_mul_f32 v55, v30, v55
    v_cvt_pk_bf16_f32 v216, v48, v49
    v_cvt_pk_bf16_f32 v217, v50, v51
    v_cvt_pk_bf16_f32 v218, v52, v53
    v_cvt_pk_bf16_f32 v219, v54, v55
    buffer_store_dwordx4 v[216:219], v29, s[60:63], s20 offen offset:1024
    v_mul_f32 v56, v30, v56
    v_mul_f32 v57, v30, v57
    v_mul_f32 v58, v30, v58
    v_mul_f32 v59, v30, v59
    v_mul_f32 v60, v30, v60
    v_mul_f32 v61, v30, v61
    v_mul_f32 v62, v30, v62
    v_mul_f32 v63, v30, v63
    v_cvt_pk_bf16_f32 v220, v56, v57
    v_cvt_pk_bf16_f32 v221, v58, v59
    v_cvt_pk_bf16_f32 v222, v60, v61
    v_cvt_pk_bf16_f32 v223, v62, v63
    buffer_store_dwordx4 v[220:223], v29, s[60:63], s20 offen offset:1536
    v_mul_f32 v64, v30, v64
    v_mul_f32 v65, v30, v65
    v_mul_f32 v66, v30, v66
    v_mul_f32 v67, v30, v67
    v_mul_f32 v68, v30, v68
    v_mul_f32 v69, v30, v69
    v_mul_f32 v70, v30, v70
    v_mul_f32 v71, v30, v71
    v_cvt_pk_bf16_f32 v224, v64, v65
    v_cvt_pk_bf16_f32 v225, v66, v67
    v_cvt_pk_bf16_f32 v226, v68, v69
    v_cvt_pk_bf16_f32 v227, v70, v71
    buffer_store_dwordx4 v[224:227], v29, s[60:63], s21 offen offset:0
    v_mul_f32 v72, v30, v72
    v_mul_f32 v73, v30, v73
    v_mul_f32 v74, v30, v74
    v_mul_f32 v75, v30, v75
    v_mul_f32 v76, v30, v76
    v_mul_f32 v77, v30, v77
    v_mul_f32 v78, v30, v78
    v_mul_f32 v79, v30, v79
    v_cvt_pk_bf16_f32 v228, v72, v73
    v_cvt_pk_bf16_f32 v229, v74, v75
    v_cvt_pk_bf16_f32 v230, v76, v77
    v_cvt_pk_bf16_f32 v231, v78, v79
    buffer_store_dwordx4 v[228:231], v29, s[60:63], s21 offen offset:512
    v_mul_f32 v80, v30, v80
    v_mul_f32 v81, v30, v81
    v_mul_f32 v82, v30, v82
    v_mul_f32 v83, v30, v83
    v_mul_f32 v84, v30, v84
    v_mul_f32 v85, v30, v85
    v_mul_f32 v86, v30, v86
    v_mul_f32 v87, v30, v87
    v_cvt_pk_bf16_f32 v232, v80, v81
    v_cvt_pk_bf16_f32 v233, v82, v83
    v_cvt_pk_bf16_f32 v234, v84, v85
    v_cvt_pk_bf16_f32 v235, v86, v87
    buffer_store_dwordx4 v[232:235], v29, s[60:63], s21 offen offset:1024
    v_mul_f32 v88, v30, v88
    v_mul_f32 v89, v30, v89
    v_mul_f32 v90, v30, v90
    v_mul_f32 v91, v30, v91
    v_mul_f32 v92, v30, v92
    v_mul_f32 v93, v30, v93
    v_mul_f32 v94, v30, v94
    v_mul_f32 v95, v30, v95
    v_cvt_pk_bf16_f32 v236, v88, v89
    v_cvt_pk_bf16_f32 v237, v90, v91
    v_cvt_pk_bf16_f32 v238, v92, v93
    v_cvt_pk_bf16_f32 v239, v94, v95
    buffer_store_dwordx4 v[236:239], v29, s[60:63], s21 offen offset:1536
a_t4:
    s_mov_b32 s6, 1
    s_waitcnt lgkmcnt(0)
    s_barrier
    ds_read_b128 v[208:211], v7
    s_cmp_eq_u32 s26, 0
    s_mov_b64 exec, 1
    s_waitcnt vmcnt(0)
    s_cbranch_scc1 fo_s
    buffer_store_dwordx2 v[4:5], v6, s[64:67], s22 offen
fo_d:
    s_mov_b64 exec, -1
a_chk:
    s_waitcnt lgkmcnt(0)
    v_or3_b32 v208, v208, v209, v210
    v_or_b32 v208, v208, v211
    s_lshl_b32 s52, s13, 12
    s_add_u32 s52, s52, 65536
    v_readfirstlane_b32 s51, v208
    v_add_u32 v24, s52, v27
    v_add_u32 v25, 1024, v24
    s_mov_b32 s9, 1
    s_cmp_lg_u32 s51, 0
    s_cbranch_scc1 a_redo
    v_xor_b32 v20, 0x8000, v20
    v_xor_b32 v21, 0x8000, v21
    v_xor_b32 v22, 0x8000, v22
    v_xor_b32 v23, 0x8000, v23
    s_mov_b32 s3, 0x10000
    v_lshl_add_u32 v55, v0, 1, 1
    v_mul_lo_u32 v55, v55, s14
    v_lshlrev_b32 v58, 2, v0
    s_and_b32 s49, s48, 3
    s_lshl_b32 s49, s49, 4
    v_and_b32 v57, 0xcc, v58
    v_or_b32 v57, s49, v57
    s_and_b32 s49, s2, 0xfc
    s_lshl_b32 s49, s49, 15
    s_lshl_b32 s50, s43, 9
    s_add_u32 s49, s49, s50
    s_lshr_b32 s50, s48, 2
    s_lshl_b32 s50, s50, 8
    s_add_u32 s49, s49, s50
    s_add_u32 s49, s49, 16777216
    s_add_u32 s50, s43, 1
    s_and_b32 s50, s50, 3
    s_mul_i32 s50, s50, 40960
    s_add_u32 s91, s50, s49
    s_add_u32 s50, s43, 2
    s_and_b32 s50, s50, 3
    s_mul_i32 s50, s50, 40960
    s_add_u32 s92, s50, s49
    s_add_u32 s50, s43, 3
    s_and_b32 s50, s50, 3
    s_mul_i32 s50, s50, 40960
    s_add_u32 s93, s50, s49
    s_lshl_b32 s49, s2, 15
    s_lshl_b32 s50, s43, 13
    s_add_u32 s49, s49, s50
    s_and_b32 s50, s48, 1
    s_lshl_b32 s50, s50, 8
    s_add_u32 s49, s49, s50
    s_lshl_b32 s50, s13, 9
    s_add_u32 s49, s49, s50
    s_add_u32 s82, s49, 16777216
    s_and_b32 s49, s44, 31
    s_or_b32 s49, s49, s48
    s_cselect_b32 s5, 99, 2
    s_branch g_common
a_redo:
    s_barrier
    v_and_b32 v1, 31, v0
    v_lshrrev_b32 v2, 5, v0
    v_and_b32 v3, 15, v0
    v_xor_b32 v3, v3, v2
    v_lshlrev_b32 v3, 4, v3
    v_lshl_add_u32 v8, v1, 8, v3
    v_xor_b32 v8, 0x10000, v8
    v_xor_b32 v9, 32, v8
    v_xor_b32 v10, 64, v8
    v_xor_b32 v11, 96, v8
    v_xor_b32 v12, 128, v8
    v_xor_b32 v13, 160, v8
    v_xor_b32 v14, 192, v8
    v_xor_b32 v15, 224, v8
    v_bfe_u32 v3, v0, 2, 2
    v_lshl_add_u32 v5, v2, 2, v3
    v_lshlrev_b32 v5, 8, v5
    v_lshl_add_u32 v5, v3, 6, v5
    v_bfe_u32 v6, v0, 4, 1
    v_lshl_add_u32 v5, v6, 5, v5
    v_and_b32 v6, 3, v0
    v_lshl_add_u32 v5, v6, 3, v5
    v_add_u32 v16, 0x18000, v5
    v_xor_b32 v17, 64, v16
    v_xor_b32 v18, 128, v16
    v_xor_b32 v19, 192, v16
    v_pk_mov_b32 v[32:33], 0, 0
    v_pk_mov_b32 v[34:35], 0, 0
    v_pk_mov_b32 v[36:37], 0, 0
    v_pk_mov_b32 v[38:39], 0, 0
    v_pk_mov_b32 v[40:41], 0, 0
    v_pk_mov_b32 v[42:43], 0, 0
    v_pk_mov_b32 v[44:45], 0, 0
    v_pk_mov_b32 v[46:47], 0, 0
    v_pk_mov_b32 v[48:49], 0, 0
    v_pk_mov_b32 v[50:51], 0, 0
    v_pk_mov_b32 v[52:53], 0, 0
    v_pk_mov_b32 v[54:55], 0, 0
    v_pk_mov_b32 v[56:57], 0, 0
    v_pk_mov_b32 v[58:59], 0, 0
    v_pk_mov_b32 v[60:61], 0, 0
    v_pk_mov_b32 v[62:63], 0, 0
    v_pk_mov_b32 v[64:65], 0, 0
    v_pk_mov_b32 v[66:67], 0, 0
    v_pk_mov_b32 v[68:69], 0, 0
    v_pk_mov_b32 v[70:71], 0, 0
    v_pk_mov_b32 v[72:73], 0, 0
    v_pk_mov_b32 v[74:75], 0, 0
    v_pk_mov_b32 v[76:77], 0, 0
    v_pk_mov_b32 v[78:79], 0, 0
    v_pk_mov_b32 v[80:81], 0, 0
    v_pk_mov_b32 v[82:83], 0, 0
    v_pk_mov_b32 v[84:85], 0, 0
    v_pk_mov_b32 v[86:87], 0, 0
    v_pk_mov_b32 v[88:89], 0, 0
    v_pk_mov_b32 v[90:91], 0, 0
    v_pk_mov_b32 v[92:93], 0, 0
    v_pk_mov_b32 v[94:95], 0, 0
    v_mov_b32 v30, 0
    v_lshlrev_b32 v3, 8, v1
    v_lshl_add_u32 v3, v2, 4, v3
    v_mov_b32 v31, 0xff800000
    s_mov_b32 s8, 1
    s_mov_b32 s10, 7
    s_mov_b32 s49, 0
    v_mov_b32 v4, s14
    v_mov_b32 v5, s15
    v_mov_b32 v6, 0
a_maxloop:
    buffer_load_dwordx4 v[176:179], v3, s[68:71], s49 offen offset:0
    buffer_load_dwordx4 v[180:183], v3, s[68:71], s49 offen offset:32
    buffer_load_dwordx4 v[184:187], v3, s[68:71], s49 offen offset:64
    buffer_load_dwordx4 v[188:191], v3, s[68:71], s49 offen offset:96
    buffer_load_dwordx4 v[192:195], v3, s[68:71], s49 offen offset:128
    buffer_load_dwordx4 v[196:199], v3, s[68:71], s49 offen offset:160
    buffer_load_dwordx4 v[200:203], v3, s[68:71], s49 offen offset:192
    buffer_load_dwordx4 v[204:207], v3, s[68:71], s49 offen offset:224
    s_waitcnt vmcnt(0)
    v_mfma_f32_32x32x16_bf16 v[144:159], v[176:179], v[112:115], 0
    v_mfma_f32_32x32x16_bf16 v[144:159], v[180:183], v[116:119], v[144:159]
    v_mfma_f32_32x32x16_bf16 v[144:159], v[184:187], v[120:123], v[144:159]
    v_mfma_f32_32x32x16_bf16 v[144:159], v[188:191], v[124:127], v[144:159]
    v_mfma_f32_32x32x16_bf16 v[144:159], v[192:195], v[128:131], v[144:159]
    v_mfma_f32_32x32x16_bf16 v[144:159], v[196:199], v[132:135], v[144:159]
    v_mfma_f32_32x32x16_bf16 v[144:159], v[200:203], v[136:139], v[144:159]
    v_mfma_f32_32x32x16_bf16 v[144:159], v[204:207], v[140:143], v[144:159]
    s_nop 15
    v_max3_f32 v31, v31, v144, v145
    v_max3_f32 v31, v31, v146, v147
    v_max3_f32 v31, v31, v148, v149
    v_max3_f32 v31, v31, v150, v151
    v_max3_f32 v31, v31, v152, v153
    v_max3_f32 v31, v31, v154, v155
    v_max3_f32 v31, v31, v156, v157
    v_max3_f32 v31, v31, v158, v159
    s_add_u32 s49, s49, 8192
    s_cmp_lt_u32 s49, 262144
    s_cbranch_scc1 a_maxloop
    v_mov_b32 v1, v31
    s_nop 1
    v_permlane32_swap_b32 v31, v1
    v_max_f32 v31, v31, v1
    v_sub_f32 v96, 0, v31
    v_sub_f32 v97, 0, v31
    v_sub_f32 v98, 0, v31
    v_sub_f32 v99, 0, v31
    v_sub_f32 v100, 0, v31
    v_sub_f32 v101, 0, v31
    v_sub_f32 v102, 0, v31
    v_sub_f32 v103, 0, v31
    v_sub_f32 v104, 0, v31
    v_sub_f32 v105, 0, v31
    v_sub_f32 v106, 0, v31
    v_sub_f32 v107, 0, v31
    v_sub_f32 v108, 0, v31
    v_sub_f32 v109, 0, v31
    v_sub_f32 v110, 0, v31
    v_sub_f32 v111, 0, v31
    s_barrier
    ds_read_b128 v[176:179], v8 offset:0
    ds_read_b128 v[180:183], v9 offset:0
    ds_read_b128 v[184:187], v10 offset:0
    ds_read_b128 v[188:191], v11 offset:0
    ds_read_b128 v[192:195], v12 offset:0
    ds_read_b128 v[196:199], v13 offset:0
    ds_read_b128 v[200:203], v14 offset:0
    ds_read_b128 v[204:207], v15 offset:0
    s_branch a_start
n_spin:
    s_mov_b32 s72, s38
    s_mov_b32 s73, s39
    s_mov_b32 s74, 256
    s_mov_b32 s75, 0x20000
    v_mov_b32 v3, 0
    s_mov_b32 s12, 0
n_sp1:
    buffer_load_dword v5, v3, s[72:75], 0 offen sc0 sc1
    s_add_u32 s12, s12, 1
    s_waitcnt vmcnt(0)
    v_readfirstlane_b32 s14, v5
    s_cmp_gt_u32 s12, 262144
    s_cbranch_scc1 n_back
    s_cmp_eq_u32 s14, 0
    s_cbranch_scc1 n_sp1
    s_branch n_back
x_spin:
    v_lshlrev_b32 v3, 2, v0
    s_mov_b32 s12, 0
    s_mov_b64 exec, 0xff
x_sp1:
    buffer_load_dword v5, v3, s[64:67], s88 offen sc1
    s_add_u32 s12, s12, 1
    s_waitcnt vmcnt(0)
    v_subrev_u32 v6, s14, v5
    v_and_b32 v6, -15, v6
    v_cmp_ne_u32 vcc, 0, v6
    s_cmp_gt_u32 s12, 262144
    s_cbranch_scc1 x_sp2
    s_cmp_lg_u64 vcc, 0
    s_cbranch_scc1 x_sp1
x_sp2:
    v_cmp_ne_u32 vcc, s86, v5
    s_mov_b64 exec, -1
    s_cmp_eq_u64 vcc, 0
    s_cselect_b32 s26, s26, 0
    s_branch x_back
h_acq_s:
    buffer_inv sc1
    s_waitcnt vmcnt(0)
    s_branch h_acq_d
fx_s:
    buffer_wbl2 sc1
    s_waitcnt vmcnt(0)
    buffer_store_dwordx2 v[4:5], v6, s[64:67], s16 offen sc1
    s_branch fx_d
h_acq1_s:
    buffer_inv sc1
    s_waitcnt vmcnt(0)
    s_branch h_acq1_d
c_acq_s:
    buffer_inv sc1
    s_waitcnt vmcnt(0)
    s_branch c_acq_d
h_acq2_s:
    buffer_inv sc1
    s_waitcnt vmcnt(0)
    s_branch h_acq2_d
g_fp:
    buffer_wbl2 sc1
    s_branch g_fpd
fq_s:
    buffer_wbl2 sc1
    s_waitcnt vmcnt(0)
    buffer_store_dwordx2 v[4:5], v6, s[64:67], s18 offen sc1
    s_branch fq_d
a_acq_s:
    buffer_inv sc1
    s_waitcnt vmcnt(0)
    s_branch a_acq_d
a_t2:
    v_mov_b32 v1, v30
    s_nop 0
    v_mfma_f32_32x32x16_bf16 v[32:47], v[224:227], v[244:247], v[32:47]
    v_permlane32_swap_b32 v30, v1
    s_nop 0
    v_add_f32 v30, v30, v1
    v_mfma_f32_32x32x16_bf16 v[48:63], v[228:231], v[244:247], v[48:63]
    v_subrev_u32 v2, 0x2b800000, v30
    v_rcp_f32 v30, v30
    v_cmp_lt_u32 vcc, s49, v2
    v_mfma_f32_32x32x16_bf16 v[64:79], v[232:235], v[244:247], v[64:79]
    s_cmp_lg_u64 vcc, 0
    s_cselect_b32 s50, 1, 0
    s_andn2_b32 s50, s50, s8
    v_mov_b32 v2, s50
    v_mfma_f32_32x32x16_bf16 v[80:95], v[236:239], v[244:247], v[80:95]
    s_branch a_t3
fo_s:
    buffer_wbl2 sc1
    s_waitcnt vmcnt(0)
    buffer_store_dwordx2 v[4:5], v6, s[64:67], s22 offen sc1
    s_branch fo_d
a_nostore:
    s_waitcnt lgkmcnt(0)
    s_barrier
    ds_read_b128 v[208:211], v7
    s_branch a_chk
c_epilogue:
    s_cmp_eq_u32 s13, s43
    s_cbranch_scc1 ce_own0
    v_cvt_pk_bf16_f32 v208, v112, v113
    v_cvt_pk_bf16_f32 v209, v114, v115
    v_cvt_pk_bf16_f32 v210, v128, v129
    v_cvt_pk_bf16_f32 v211, v130, v131
    buffer_store_dwordx4 v[208:211], v27, s[64:67], s23 offen offset:0 sc1
    v_cvt_pk_bf16_f32 v216, v116, v117
    v_cvt_pk_bf16_f32 v217, v118, v119
    v_cvt_pk_bf16_f32 v218, v132, v133
    v_cvt_pk_bf16_f32 v219, v134, v135
    buffer_store_dwordx4 v[216:219], v27, s[64:67], s23 offen offset:2048 sc1
    s_nop 2
    v_cvt_pk_bf16_f32 v212, v144, v145
    v_cvt_pk_bf16_f32 v213, v146, v147
    v_cvt_pk_bf16_f32 v214, v160, v161
    v_cvt_pk_bf16_f32 v215, v162, v163
    buffer_store_dwordx4 v[212:215], v27, s[64:67], s23 offen offset:1024 sc1
    v_cvt_pk_bf16_f32 v220, v148, v149
    v_cvt_pk_bf16_f32 v221, v150, v151
    v_cvt_pk_bf16_f32 v222, v164, v165
    v_cvt_pk_bf16_f32 v223, v166, v167
    buffer_store_dwordx4 v[220:223], v27, s[64:67], s23 offen offset:3072 sc1
    s_branch ce_nx0
ce_own0:
    ds_write_b128 v250, v[112:115] offset:0
    ds_write_b128 v250, v[116:119] offset:4096
    ds_write_b128 v250, v[128:131] offset:1024
    ds_write_b128 v250, v[132:135] offset:5120
    ds_write_b128 v250, v[144:147] offset:2048
    ds_write_b128 v250, v[148:151] offset:6144
    ds_write_b128 v250, v[160:163] offset:3072
    ds_write_b128 v250, v[164:167] offset:7168
ce_nx0:
    s_add_u32 s13, s13, 1
    s_add_u32 s23, s23, 8192
    s_cmp_eq_u32 s13, s43
    s_cbranch_scc1 ce_own1
    v_cvt_pk_bf16_f32 v224, v120, v121
    v_cvt_pk_bf16_f32 v225, v122, v123
    v_cvt_pk_bf16_f32 v226, v136, v137
    v_cvt_pk_bf16_f32 v227, v138, v139
    buffer_store_dwordx4 v[224:227], v27, s[64:67], s23 offen offset:0 sc1
    v_cvt_pk_bf16_f32 v232, v124, v125
    v_cvt_pk_bf16_f32 v233, v126, v127
    v_cvt_pk_bf16_f32 v234, v140, v141
    v_cvt_pk_bf16_f32 v235, v142, v143
    buffer_store_dwordx4 v[232:235], v27, s[64:67], s23 offen offset:2048 sc1
    v_cvt_pk_bf16_f32 v228, v152, v153
    v_cvt_pk_bf16_f32 v229, v154, v155
    v_cvt_pk_bf16_f32 v230, v168, v169
    v_cvt_pk_bf16_f32 v231, v170, v171
    buffer_store_dwordx4 v[228:231], v27, s[64:67], s23 offen offset:1024 sc1
    v_cvt_pk_bf16_f32 v236, v156, v157
    v_cvt_pk_bf16_f32 v237, v158, v159
    v_cvt_pk_bf16_f32 v238, v172, v173
    v_cvt_pk_bf16_f32 v239, v174, v175
    buffer_store_dwordx4 v[236:239], v27, s[64:67], s23 offen offset:3072 sc1
    s_branch ce_nx1
ce_own1:
    ds_write_b128 v250, v[120:123] offset:0
    ds_write_b128 v250, v[124:127] offset:4096
    ds_write_b128 v250, v[136:139] offset:1024
    ds_write_b128 v250, v[140:143] offset:5120
    ds_write_b128 v250, v[152:155] offset:2048
    ds_write_b128 v250, v[156:159] offset:6144
    ds_write_b128 v250, v[168:171] offset:3072
    ds_write_b128 v250, v[172:175] offset:7168
ce_nx1:
    s_waitcnt lgkmcnt(0)
    s_sub_u32 s49, s13, 1
    s_cmp_eq_u32 s49, s43
    s_cbranch_scc1 ck_n0
    v_add_u32 v176, v208, v55
    v_add_u32 v180, v212, v55
    v_add_u32 v184, v216, v55
    v_add_u32 v188, v220, v55
    v_add_u32 v177, v209, v55
    v_add_u32 v181, v213, v55
    v_add_u32 v185, v217, v55
    v_add_u32 v189, v221, v55
    v_add_u32 v178, v210, v55
    v_add_u32 v182, v214, v55
    v_add_u32 v186, v218, v55
    v_add_u32 v190, v222, v55
    v_add_u32 v179, v211, v55
    v_add_u32 v183, v215, v55
    v_add_u32 v187, v219, v55
    v_add_u32 v191, v223, v55
    v_alignbit_b32 v177, v177, v177, 7
    v_alignbit_b32 v181, v181, v181, 7
    v_alignbit_b32 v185, v185, v185, 7
    v_alignbit_b32 v189, v189, v189, 7
    v_alignbit_b32 v178, v178, v178, 14
    v_alignbit_b32 v182, v182, v182, 14
    v_alignbit_b32 v186, v186, v186, 14
    v_alignbit_b32 v190, v190, v190, 14
    v_alignbit_b32 v179, v179, v179, 21
    v_alignbit_b32 v183, v183, v183, 21
    v_alignbit_b32 v187, v187, v187, 21
    v_alignbit_b32 v191, v191, v191, 21
    v_xor_b32 v178, v178, v179
    v_xor_b32 v182, v182, v183
    v_xor_b32 v186, v186, v187
    v_xor_b32 v190, v190, v191
    v_xad_u32 v176, v176, v177, v178
    v_xad_u32 v180, v180, v181, v182
    v_xad_u32 v184, v184, v185, v186
    v_xad_u32 v188, v188, v189, v190
    v_alignbit_b32 v176, v176, v176, v0
    v_alignbit_b32 v180, v180, v180, v0
    v_alignbit_b32 v184, v184, v184, v0
    v_alignbit_b32 v188, v188, v188, v0
    v_add_u32_dpp v176, v176, v176 row_ror:4 row_mask:0xf bank_mask:0xf
    v_add_u32_dpp v180, v180, v180 row_ror:4 row_mask:0xf bank_mask:0xf
    v_add_u32_dpp v184, v184, v184 row_ror:4 row_mask:0xf bank_mask:0xf
    v_add_u32_dpp v188, v188, v188 row_ror:4 row_mask:0xf bank_mask:0xf
    v_add_u32_dpp v192, v176, v176 row_ror:8 row_mask:0xf bank_mask:0x1
    v_add_u32_dpp v192, v180, v180 row_ror:8 row_mask:0xf bank_mask:0x2
    v_add_u32_dpp v192, v184, v184 row_ror:8 row_mask:0xf bank_mask:0x4
    v_add_u32_dpp v192, v188, v188 row_ror:8 row_mask:0xf bank_mask:0x8
    buffer_store_dword v192, v58, s[64:67], s82 offen offset:0 sc1
ck_n0:
    s_sub_u32 s49, s13, 0
    s_cmp_eq_u32 s49, s43
    s_cbranch_scc1 ck_n1
    v_add_u32 v176, v224, v55
    v_add_u32 v180, v228, v55
    v_add_u32 v184, v232, v55
    v_add_u32 v188, v236, v55
    v_add_u32 v177, v225, v55
    v_add_u32 v181, v229, v55
    v_add_u32 v185, v233, v55
    v_add_u32 v189, v237, v55
    v_add_u32 v178, v226, v55
    v_add_u32 v182, v230, v55
    v_add_u32 v186, v234, v55
    v_add_u32 v190, v238, v55
    v_add_u32 v179, v227, v55
    v_add_u32 v183, v231, v55
    v_add_u32 v187, v235, v55
    v_add_u32 v191, v239, v55
    v_alignbit_b32 v177, v177, v177, 7
    v_alignbit_b32 v181, v181, v181, 7
    v_alignbit_b32 v185, v185, v185, 7
    v_alignbit_b32 v189, v189, v189, 7
    v_alignbit_b32 v178, v178, v178, 14
    v_alignbit_b32 v182, v182, v182, 14
    v_alignbit_b32 v186, v186, v186, 14
    v_alignbit_b32 v190, v190, v190, 14
    v_alignbit_b32 v179, v179, v179, 21
    v_alignbit_b32 v183, v183, v183, 21
    v_alignbit_b32 v187, v187, v187, 21
    v_alignbit_b32 v191, v191, v191, 21
    v_xor_b32 v178, v178, v179
    v_xor_b32 v182, v182, v183
    v_xor_b32 v186, v186, v187
    v_xor_b32 v190, v190, v191
    v_xad_u32 v176, v176, v177, v178
    v_xad_u32 v180, v180, v181, v182
    v_xad_u32 v184, v184, v185, v186
    v_xad_u32 v188, v188, v189, v190
    v_alignbit_b32 v176, v176, v176, v0
    v_alignbit_b32 v180, v180, v180, v0
    v_alignbit_b32 v184, v184, v184, v0
    v_alignbit_b32 v188, v188, v188, v0
    v_add_u32_dpp v176, v176, v176 row_ror:4 row_mask:0xf bank_mask:0xf
    v_add_u32_dpp v180, v180, v180 row_ror:4 row_mask:0xf bank_mask:0xf
    v_add_u32_dpp v184, v184, v184 row_ror:4 row_mask:0xf bank_mask:0xf
    v_add_u32_dpp v188, v188, v188 row_ror:4 row_mask:0xf bank_mask:0xf
    v_add_u32_dpp v193, v176, v176 row_ror:8 row_mask:0xf bank_mask:0x1
    v_add_u32_dpp v193, v180, v180 row_ror:8 row_mask:0xf bank_mask:0x2
    v_add_u32_dpp v193, v184, v184 row_ror:8 row_mask:0xf bank_mask:0x4
    v_add_u32_dpp v193, v188, v188 row_ror:8 row_mask:0xf bank_mask:0x8
    buffer_store_dword v193, v58, s[64:67], s82 offen offset:512 sc1
ck_n1:
    s_waitcnt lgkmcnt(0)
c_final:
    s_add_u32 s53, s43, 1
    s_and_b32 s53, s53, 3
    s_lshl_b32 s53, s53, 15
    s_add_u32 s49, s53, s0
    s_add_u32 s53, s43, 2
    s_and_b32 s53, s53, 3
    s_lshl_b32 s53, s53, 15
    s_add_u32 s50, s53, s0
    s_add_u32 s53, s43, 3
    s_and_b32 s53, s53, 3
    s_lshl_b32 s53, s53, 15
    s_add_u32 s52, s53, s0
    s_mov_b32 s12, 0
    s_barrier
    buffer_load_dwordx4 v[40:43], v27, s[64:67], s49 offen sc1
    buffer_load_dword v52, v57, s[64:67], s91 offen sc1
    buffer_load_dwordx4 v[44:47], v27, s[64:67], s50 offen sc1
    buffer_load_dword v53, v57, s[64:67], s92 offen sc1
    buffer_load_dwordx4 v[48:51], v27, s[64:67], s52 offen sc1
    buffer_load_dword v54, v57, s[64:67], s93 offen sc1
    ds_read_b128 v[32:35], v248
    ds_read_b128 v[36:39], v248 offset:1024
    s_waitcnt lgkmcnt(0)
    s_waitcnt vmcnt(4)
cf_t0:
    v_add_u32 v60, v40, v55
    v_add_u32 v61, v41, v55
    v_add_u32 v62, v42, v55
    v_add_u32 v63, v43, v55
    v_alignbit_b32 v61, v61, v61, 7
    v_alignbit_b32 v62, v62, v62, 14
    v_alignbit_b32 v63, v63, v63, 21
    v_xor_b32 v62, v62, v63
    v_xad_u32 v60, v60, v61, v62
    v_alignbit_b32 v60, v60, v60, v0
    s_nop 1
    v_add_u32_dpp v60, v60, v60 row_ror:4 row_mask:0xf bank_mask:0xf
    s_nop 1
    v_add_u32_dpp v60, v60, v60 row_ror:8 row_mask:0xf bank_mask:0xf
    v_cmp_ne_u32 vcc, v60, v52
    s_cbranch_vccz cf_ok0
    s_add_u32 s12, s12, 1
    s_cmp_gt_u32 s12, 262144
    s_cbranch_scc1 cf_ok0
    s_waitcnt vmcnt(0)
    buffer_load_dwordx4 v[40:43], v27, s[64:67], s49 offen sc1
    buffer_load_dword v52, v57, s[64:67], s91 offen sc1
    buffer_load_dwordx4 v[44:47], v27, s[64:67], s50 offen sc1
    buffer_load_dword v53, v57, s[64:67], s92 offen sc1
    buffer_load_dwordx4 v[48:51], v27, s[64:67], s52 offen sc1
    buffer_load_dword v54, v57, s[64:67], s93 offen sc1
    s_waitcnt vmcnt(4)
    s_branch cf_t0
cf_ok0:
    v_lshlrev_b32 v8, 16, v40
    v_and_b32 v9, 0xffff0000, v40
    v_add_f32 v32, v32, v8
    v_add_f32 v33, v33, v9
    v_lshlrev_b32 v8, 16, v41
    v_and_b32 v9, 0xffff0000, v41
    v_add_f32 v34, v34, v8
    v_add_f32 v35, v35, v9
    v_lshlrev_b32 v8, 16, v42
    v_and_b32 v9, 0xffff0000, v42
    v_add_f32 v36, v36, v8
    v_add_f32 v37, v37, v9
    v_lshlrev_b32 v8, 16, v43
    v_and_b32 v9, 0xffff0000, v43
    v_add_f32 v38, v38, v8
    v_add_f32 v39, v39, v9
    s_waitcnt vmcnt(2)
cf_t1:
    v_add_u32 v60, v44, v55
    v_add_u32 v61, v45, v55
    v_add_u32 v62, v46, v55
    v_add_u32 v63, v47, v55
    v_alignbit_b32 v61, v61, v61, 7
    v_alignbit_b32 v62, v62, v62, 14
    v_alignbit_b32 v63, v63, v63, 21
    v_xor_b32 v62, v62, v63
    v_xad_u32 v60, v60, v61, v62
    v_alignbit_b32 v60, v60, v60, v0
    s_nop 1
    v_add_u32_dpp v60, v60, v60 row_ror:4 row_mask:0xf bank_mask:0xf
    s_nop 1
    v_add_u32_dpp v60, v60, v60 row_ror:8 row_mask:0xf bank_mask:0xf
    v_cmp_ne_u32 vcc, v60, v53
    s_cbranch_vccz cf_ok1
    s_add_u32 s12, s12, 1
    s_cmp_gt_u32 s12, 262144
    s_cbranch_scc1 cf_ok1
    s_waitcnt vmcnt(0)
    buffer_load_dwordx4 v[44:47], v27, s[64:67], s50 offen sc1
    buffer_load_dword v53, v57, s[64:67], s92 offen sc1
    buffer_load_dwordx4 v[48:51], v27, s[64:67], s52 offen sc1
    buffer_load_dword v54, v57, s[64:67], s93 offen sc1
    s_waitcnt vmcnt(2)
    s_branch cf_t1
cf_ok1:
    v_lshlrev_b32 v8, 16, v44
    v_and_b32 v9, 0xffff0000, v44
    v_add_f32 v32, v32, v8
    v_add_f32 v33, v33, v9
    v_lshlrev_b32 v8, 16, v45
    v_and_b32 v9, 0xffff0000, v45
    v_add_f32 v34, v34, v8
    v_add_f32 v35, v35, v9
    v_lshlrev_b32 v8, 16, v46
    v_and_b32 v9, 0xffff0000, v46
    v_add_f32 v36, v36, v8
    v_add_f32 v37, v37, v9
    v_lshlrev_b32 v8, 16, v47
    v_and_b32 v9, 0xffff0000, v47
    v_add_f32 v38, v38, v8
    v_add_f32 v39, v39, v9
    s_waitcnt vmcnt(0)
cf_t2:
    v_add_u32 v60, v48, v55
    v_add_u32 v61, v49, v55
    v_add_u32 v62, v50, v55
    v_add_u32 v63, v51, v55
    v_alignbit_b32 v61, v61, v61, 7
    v_alignbit_b32 v62, v62, v62, 14
    v_alignbit_b32 v63, v63, v63, 21
    v_xor_b32 v62, v62, v63
    v_xad_u32 v60, v60, v61, v62
    v_alignbit_b32 v60, v60, v60, v0
    s_nop 1
    v_add_u32_dpp v60, v60, v60 row_ror:4 row_mask:0xf bank_mask:0xf
    s_nop 1
    v_add_u32_dpp v60, v60, v60 row_ror:8 row_mask:0xf bank_mask:0xf
    v_cmp_ne_u32 vcc, v60, v54
    s_cbranch_vccz cf_ok2
    s_add_u32 s12, s12, 1
    s_cmp_gt_u32 s12, 262144
    s_cbranch_scc1 cf_ok2
    buffer_load_dwordx4 v[48:51], v27, s[64:67], s52 offen sc1
    buffer_load_dword v54, v57, s[64:67], s93 offen sc1
    s_waitcnt vmcnt(0)
    s_branch cf_t2
cf_ok2:
    v_lshlrev_b32 v8, 16, v48
    v_and_b32 v9, 0xffff0000, v48
    v_add_f32 v32, v32, v8
    v_add_f32 v33, v33, v9
    v_lshlrev_b32 v8, 16, v49
    v_and_b32 v9, 0xffff0000, v49
    v_add_f32 v34, v34, v8
    v_add_f32 v35, v35, v9
    v_lshlrev_b32 v8, 16, v50
    v_and_b32 v9, 0xffff0000, v50
    v_add_f32 v36, v36, v8
    v_add_f32 v37, v37, v9
    v_lshlrev_b32 v8, 16, v51
    v_and_b32 v9, 0xffff0000, v51
    v_add_f32 v38, v38, v8
    v_add_f32 v39, v39, v9
    v_cvt_pk_bf16_f32 v12, v32, v33
    v_cvt_pk_bf16_f32 v14, v36, v37
    v_cvt_pk_bf16_f32 v13, v34, v35
    v_cvt_pk_bf16_f32 v15, v38, v39
    v_permlane16_swap_b32 v12, v14
    s_nop 0
    v_permlane16_swap_b32 v13, v15
    buffer_store_dwordx4 v[12:15], v249, s[32:35], s1 offen sc1
L_fin:
L_end:
    s_endpgm

.section .rodata,"a"
.p2align 6
.amdhsa_kernel concat_heads__gqa_block_cached__gqa_block_cached__near_ridge_kernel
  .amdhsa_next_free_vgpr 256
  .amdhsa_next_free_sgpr 102
  .amdhsa_accum_offset 256
  .amdhsa_group_segment_fixed_size 0
  .amdhsa_kernarg_size 104
  .amdhsa_user_sgpr_count 2
  .amdhsa_user_sgpr_kernarg_segment_ptr 1
  .amdhsa_system_sgpr_workgroup_id_x 1
.end_amdhsa_kernel
```
